```python
import torch

def _softmax(x, axis=-1):
    return torch.softmax(x, dim=axis)
def _gelu(x):
    return torch.nn.functional.gelu(x, approximate="tanh")
def _silu(x):
    return torch.nn.functional.silu(x)
def _sigmoid(x):
    return torch.sigmoid(x)
def _layernorm(x, axis=-1, eps=1e-5):
    m = x.mean(dim=axis, keepdim=True)
    v = x.var(dim=axis, keepdim=True, unbiased=False)
    return (x - m) / torch.sqrt(v + eps)
def _scatter_add(tgt, idx, src, axis=0):
    return tgt.clone().index_add_(axis, idx, src)
def _segment_sum(src, seg, n):
    out = torch.zeros((n,) + src.shape[1:], dtype=src.dtype)
    return out.index_add_(0, seg, src)
def _pad(x, pw):
    flat = tuple(v for pair in reversed(pw) for v in pair)
    return torch.nn.functional.pad(x, flat)

kernel_name = 'parallel_sum__grouped_kv_mqa__swiglu_ffn__prompt'

def setup_inputs():

    _w = (lambda a: (lambda t: t.to(torch.bfloat16) if t.is_floating_point() else t)(torch.as_tensor(a)))
    def _A_setup():
        B, S, D, H = 1, 2048, 640, 32
        Dh = D // H
        return {
            "x": _w((lambda *s: torch.randn(*s, dtype=torch.bfloat16) * 0.05)(B, S, D)),
            "wq": _w((lambda *s: torch.randn(*s, dtype=torch.bfloat16) * 0.2)(D, H * Dh)),
            "wk": _w((lambda *s: torch.randn(*s, dtype=torch.bfloat16) * 0.2)(D, Dh)),
            "wv": _w((lambda *s: torch.randn(*s, dtype=torch.bfloat16) * 0.1)(D, Dh)),
            "wo": _w((lambda *s: torch.randn(*s, dtype=torch.bfloat16) * 0.1)(H * Dh, D)),
        }
    _A_in = _A_setup()

    def _B_setup():
        B, S, D, F = 1, 2048, 640, 1728
        return {
            "x": _w((lambda *s: torch.randn(*s, dtype=torch.bfloat16) * 0.05)(B, S, D)),
            "w_gate": _w((lambda *s: torch.randn(*s, dtype=torch.bfloat16) * 0.1)(D, F)),
            "w_up": _w((lambda *s: torch.randn(*s, dtype=torch.bfloat16) * 0.1)(D, F)),
            "w_down": _w((lambda *s: torch.randn(*s, dtype=torch.bfloat16) * 0.1)(F, D)),
        }
    _B_in = _B_setup()

    return {
        "A_x": _A_in["x"],
        "A_wq": _A_in["wq"],
        "A_wk": _A_in["wk"],
        "A_wv": _A_in["wv"],
        "A_wo": _A_in["wo"],
        "B_x": _B_in["x"],
        "B_w_gate": _B_in["w_gate"],
        "B_w_up": _B_in["w_up"],
        "B_w_down": _B_in["w_down"],
    }

def reference(A_x, A_wq, A_wk, A_wv, A_wo, B_x, B_w_gate, B_w_up, B_w_down):
    def _A_ref(x, wq, wk, wv, wo):
        B, S, D = x.shape
        H = 32
        Dh = D // H
        q = (lambda x, *d: x.permute(*d))((x @ wq).reshape(B, S, H, Dh), 0, 2, 1, 3)
        k = x @ wk
        v = x @ wv
        scores = torch.einsum("bhqd,bkd->bhqk", q, k) * (Dh ** -0.5)
        p = _softmax(scores, axis=-1)
        o = torch.einsum("bhqk,bkd->bhqd", p, v)
        return (lambda x, *d: x.permute(*d))(o, 0, 2, 1, 3).reshape(B, S, H * Dh) @ wo

    def _B_ref(x, w_gate, w_up, w_down):
        g = _silu(x @ w_gate)
        u = x @ w_up
        return (g * u) @ w_down

    x = A_x
    xn = _layernorm(x, axis=-1)
    return x + _A_ref(xn, A_wq, A_wk, A_wv, A_wo) + _B_ref(xn, B_w_gate, B_w_up, B_w_down)
```

```asm
; @launch kernel=k0_ln_kv_kernel grid=(396,1,1) block=(512,1,1) lds=72704
; @launch kernel=kf_attgu_kernel grid=(512,1,1) block=(256,1,1) lds=49152
; @launch kernel=k3_out_kernel grid=(256,1,1) block=(256,1,1) lds=73728
.amdgcn_target "amdgcn-amd-amdhsa--gfx950"
.text
.globl k0_ln_kv_kernel
.p2align 8
.type k0_ln_kv_kernel,@function
k0_ln_kv_kernel:
  s_cmp_ge_u32 s2, 396
  s_cbranch_scc1 L_k0_ln_kv_kernel_end
  s_cmp_ge_u32 s2, 128
  s_cbranch_scc1 L_k0_pack
  s_load_dwordx2 s[4:5], s[0:1], 0
  s_load_dwordx4 s[8:11], s[0:1], 16
  s_load_dwordx2 s[12:13], s[0:1], 88
  v_and_b32 v1, 63, v0
  v_lshrrev_b32 v2, 6, v0
  v_and_b32 v3, 31, v0
  v_readfirstlane_b32 s3, v2
  v_lshrrev_b32 v4, 5, v0
  s_lshl_b32 s16, s2, 4
  v_add_u32 v5, s16, v4
  v_mul_u32_u24 v5, 1280, v5
  v_lshl_add_u32 v6, v3, 4, v5
  v_lshl_add_u32 v7, v3, 3, v5
  v_lshlrev_b32 v8, 4, v1
  s_waitcnt lgkmcnt(0)
  global_load_dwordx4 v[10:13], v6, s[4:5]
  global_load_dwordx4 v[14:17], v6, s[4:5] offset:512
  global_load_dwordx2 v[18:19], v7, s[4:5] offset:1024
  s_sub_u32 s14, s10, 25600
  s_subb_u32 s15, s11, 0
  s_add_u32 s20, s3, 0
  s_lshl_b32 s21, s20, 10
  s_cmp_lt_u32 s20, 25
  s_cselect_b32 s22, s8, s14
  s_cselect_b32 s23, s9, s15
  s_add_u32 s22, s22, s21
  s_addc_u32 s23, s23, 0
  s_add_u32 m0, s21, 20480
  s_nop 0
  global_load_lds_dwordx4 v8, s[22:23]
  s_add_u32 s20, s3, 8
  s_lshl_b32 s21, s20, 10
  s_cmp_lt_u32 s20, 25
  s_cselect_b32 s22, s8, s14
  s_cselect_b32 s23, s9, s15
  s_add_u32 s22, s22, s21
  s_addc_u32 s23, s23, 0
  s_add_u32 m0, s21, 20480
  s_nop 0
  global_load_lds_dwordx4 v8, s[22:23]
  s_add_u32 s20, s3, 16
  s_lshl_b32 s21, s20, 10
  s_cmp_lt_u32 s20, 25
  s_cselect_b32 s22, s8, s14
  s_cselect_b32 s23, s9, s15
  s_add_u32 s22, s22, s21
  s_addc_u32 s23, s23, 0
  s_add_u32 m0, s21, 20480
  s_nop 0
  global_load_lds_dwordx4 v8, s[22:23]
  s_add_u32 s20, s3, 24
  s_lshl_b32 s21, s20, 10
  s_cmp_lt_u32 s20, 25
  s_cselect_b32 s22, s8, s14
  s_cselect_b32 s23, s9, s15
  s_add_u32 s22, s22, s21
  s_addc_u32 s23, s23, 0
  s_add_u32 m0, s21, 20480
  s_nop 0
  global_load_lds_dwordx4 v8, s[22:23]
  s_add_u32 s20, s3, 32
  s_lshl_b32 s21, s20, 10
  s_cmp_lt_u32 s20, 25
  s_cselect_b32 s22, s8, s14
  s_cselect_b32 s23, s9, s15
  s_add_u32 s22, s22, s21
  s_addc_u32 s23, s23, 0
  s_add_u32 m0, s21, 20480
  s_nop 0
  global_load_lds_dwordx4 v8, s[22:23]
  s_add_u32 s20, s3, 40
  s_lshl_b32 s21, s20, 10
  s_cmp_lt_u32 s20, 25
  s_cselect_b32 s22, s8, s14
  s_cselect_b32 s23, s9, s15
  s_add_u32 s22, s22, s21
  s_addc_u32 s23, s23, 0
  s_add_u32 m0, s21, 20480
  s_nop 0
  global_load_lds_dwordx4 v8, s[22:23]
  s_add_u32 s20, s3, 48
  s_cmp_lt_u32 s20, 50
  s_cbranch_scc0 L_k0_nodma
  s_lshl_b32 s21, s20, 10
  s_cmp_lt_u32 s20, 25
  s_cselect_b32 s22, s8, s14
  s_cselect_b32 s23, s9, s15
  s_add_u32 s22, s22, s21
  s_addc_u32 s23, s23, 0
  s_add_u32 m0, s21, 20480
  s_nop 0
  global_load_lds_dwordx4 v8, s[22:23]
L_k0_nodma:
  s_waitcnt vmcnt(6)
  v_lshlrev_b32 v20, 16, v10
  v_and_b32 v21, 0xffff0000, v10
  v_lshlrev_b32 v22, 16, v11
  v_and_b32 v23, 0xffff0000, v11
  v_lshlrev_b32 v24, 16, v12
  v_and_b32 v25, 0xffff0000, v12
  v_lshlrev_b32 v26, 16, v13
  v_and_b32 v27, 0xffff0000, v13
  v_lshlrev_b32 v28, 16, v14
  v_and_b32 v29, 0xffff0000, v14
  v_lshlrev_b32 v30, 16, v15
  v_and_b32 v31, 0xffff0000, v15
  v_lshlrev_b32 v32, 16, v16
  v_and_b32 v33, 0xffff0000, v16
  v_lshlrev_b32 v34, 16, v17
  v_and_b32 v35, 0xffff0000, v17
  v_lshlrev_b32 v36, 16, v18
  v_and_b32 v37, 0xffff0000, v18
  v_lshlrev_b32 v38, 16, v19
  v_and_b32 v39, 0xffff0000, v19
  v_add_f32 v40, v20, v21
  v_add_f32 v41, v22, v23
  v_add_f32 v40, v40, v24
  v_add_f32 v41, v41, v25
  v_add_f32 v40, v40, v26
  v_add_f32 v41, v41, v27
  v_add_f32 v40, v40, v28
  v_add_f32 v41, v41, v29
  v_add_f32 v40, v40, v30
  v_add_f32 v41, v41, v31
  v_add_f32 v40, v40, v32
  v_add_f32 v41, v41, v33
  v_add_f32 v40, v40, v34
  v_add_f32 v41, v41, v35
  v_add_f32 v40, v40, v36
  v_add_f32 v41, v41, v37
  v_add_f32 v40, v40, v38
  v_add_f32 v41, v41, v39
  v_add_f32 v40, v40, v41
  s_nop 1
  v_add_f32_dpp v40, v40, v40 row_ror:8 row_mask:0xf bank_mask:0xf
  s_nop 1
  v_add_f32_dpp v40, v40, v40 row_ror:4 row_mask:0xf bank_mask:0xf
  s_nop 1
  v_add_f32_dpp v40, v40, v40 row_ror:2 row_mask:0xf bank_mask:0xf
  s_nop 1
  v_add_f32_dpp v40, v40, v40 row_ror:1 row_mask:0xf bank_mask:0xf
  v_mov_b32 v41, v40
  s_nop 1
  v_permlane16_swap_b32 v40, v41
  v_add_f32 v40, v40, v41
  v_mul_f32 v40, 0x3acccccd, v40
  v_mov_b32 v42, 0
  v_mov_b32 v43, 0
  v_sub_f32 v44, v20, v40
  v_sub_f32 v45, v21, v40
  v_fma_f32 v42, v44, v44, v42
  v_fma_f32 v43, v45, v45, v43
  v_sub_f32 v44, v22, v40
  v_sub_f32 v45, v23, v40
  v_fma_f32 v42, v44, v44, v42
  v_fma_f32 v43, v45, v45, v43
  v_sub_f32 v44, v24, v40
  v_sub_f32 v45, v25, v40
  v_fma_f32 v42, v44, v44, v42
  v_fma_f32 v43, v45, v45, v43
  v_sub_f32 v44, v26, v40
  v_sub_f32 v45, v27, v40
  v_fma_f32 v42, v44, v44, v42
  v_fma_f32 v43, v45, v45, v43
  v_sub_f32 v44, v28, v40
  v_sub_f32 v45, v29, v40
  v_fma_f32 v42, v44, v44, v42
  v_fma_f32 v43, v45, v45, v43
  v_sub_f32 v44, v30, v40
  v_sub_f32 v45, v31, v40
  v_fma_f32 v42, v44, v44, v42
  v_fma_f32 v43, v45, v45, v43
  v_sub_f32 v44, v32, v40
  v_sub_f32 v45, v33, v40
  v_fma_f32 v42, v44, v44, v42
  v_fma_f32 v43, v45, v45, v43
  v_sub_f32 v44, v34, v40
  v_sub_f32 v45, v35, v40
  v_fma_f32 v42, v44, v44, v42
  v_fma_f32 v43, v45, v45, v43
  v_sub_f32 v44, v36, v40
  v_sub_f32 v45, v37, v40
  v_fma_f32 v42, v44, v44, v42
  v_fma_f32 v43, v45, v45, v43
  v_sub_f32 v44, v38, v40
  v_sub_f32 v45, v39, v40
  v_fma_f32 v42, v44, v44, v42
  v_fma_f32 v43, v45, v45, v43
  v_add_f32 v42, v42, v43
  s_nop 1
  v_add_f32_dpp v42, v42, v42 row_ror:8 row_mask:0xf bank_mask:0xf
  s_nop 1
  v_add_f32_dpp v42, v42, v42 row_ror:4 row_mask:0xf bank_mask:0xf
  s_nop 1
  v_add_f32_dpp v42, v42, v42 row_ror:2 row_mask:0xf bank_mask:0xf
  s_nop 1
  v_add_f32_dpp v42, v42, v42 row_ror:1 row_mask:0xf bank_mask:0xf
  v_mov_b32 v43, v42
  s_nop 1
  v_permlane16_swap_b32 v42, v43
  v_add_f32 v42, v42, v43
  v_mul_f32 v42, 0x3acccccd, v42
  v_cvt_pk_bf16_f32 v40, v40, v40
  v_and_b32 v40, 0xffff0000, v40
  v_cvt_pk_bf16_f32 v42, v42, v42
  v_and_b32 v42, 0xffff0000, v42
  v_add_f32 v42, 0x3727c5ac, v42
  v_cvt_pk_bf16_f32 v42, v42, v42
  v_and_b32 v42, 0xffff0000, v42
  v_sqrt_f32 v42, v42
  s_nop 0
  v_cvt_pk_bf16_f32 v42, v42, v42
  v_and_b32 v42, 0xffff0000, v42
  v_rcp_f32 v43, v42
  s_nop 0
  v_fma_f32 v44, -v42, v43, 1.0
  v_fma_f32 v43, v43, v44, v43
  v_sub_f32 v44, v20, v40
  v_sub_f32 v45, v21, v40
  v_cvt_pk_bf16_f32 v44, v44, v45
  v_and_b32 v45, 0xffff0000, v44
  v_lshlrev_b32 v44, 16, v44
  v_mul_f32 v45, v45, v43
  v_mul_f32 v44, v44, v43
  v_cvt_pk_bf16_f32 v10, v44, v45
  v_sub_f32 v44, v22, v40
  v_sub_f32 v45, v23, v40
  v_cvt_pk_bf16_f32 v44, v44, v45
  v_and_b32 v45, 0xffff0000, v44
  v_lshlrev_b32 v44, 16, v44
  v_mul_f32 v45, v45, v43
  v_mul_f32 v44, v44, v43
  v_cvt_pk_bf16_f32 v11, v44, v45
  v_sub_f32 v44, v24, v40
  v_sub_f32 v45, v25, v40
  v_cvt_pk_bf16_f32 v44, v44, v45
  v_and_b32 v45, 0xffff0000, v44
  v_lshlrev_b32 v44, 16, v44
  v_mul_f32 v45, v45, v43
  v_mul_f32 v44, v44, v43
  v_cvt_pk_bf16_f32 v12, v44, v45
  v_sub_f32 v44, v26, v40
  v_sub_f32 v45, v27, v40
  v_cvt_pk_bf16_f32 v44, v44, v45
  v_and_b32 v45, 0xffff0000, v44
  v_lshlrev_b32 v44, 16, v44
  v_mul_f32 v45, v45, v43
  v_mul_f32 v44, v44, v43
  v_cvt_pk_bf16_f32 v13, v44, v45
  v_sub_f32 v44, v28, v40
  v_sub_f32 v45, v29, v40
  v_cvt_pk_bf16_f32 v44, v44, v45
  v_and_b32 v45, 0xffff0000, v44
  v_lshlrev_b32 v44, 16, v44
  v_mul_f32 v45, v45, v43
  v_mul_f32 v44, v44, v43
  v_cvt_pk_bf16_f32 v14, v44, v45
  v_sub_f32 v44, v30, v40
  v_sub_f32 v45, v31, v40
  v_cvt_pk_bf16_f32 v44, v44, v45
  v_and_b32 v45, 0xffff0000, v44
  v_lshlrev_b32 v44, 16, v44
  v_mul_f32 v45, v45, v43
  v_mul_f32 v44, v44, v43
  v_cvt_pk_bf16_f32 v15, v44, v45
  v_sub_f32 v44, v32, v40
  v_sub_f32 v45, v33, v40
  v_cvt_pk_bf16_f32 v44, v44, v45
  v_and_b32 v45, 0xffff0000, v44
  v_lshlrev_b32 v44, 16, v44
  v_mul_f32 v45, v45, v43
  v_mul_f32 v44, v44, v43
  v_cvt_pk_bf16_f32 v16, v44, v45
  v_sub_f32 v44, v34, v40
  v_sub_f32 v45, v35, v40
  v_cvt_pk_bf16_f32 v44, v44, v45
  v_and_b32 v45, 0xffff0000, v44
  v_lshlrev_b32 v44, 16, v44
  v_mul_f32 v45, v45, v43
  v_mul_f32 v44, v44, v43
  v_cvt_pk_bf16_f32 v17, v44, v45
  v_sub_f32 v44, v36, v40
  v_sub_f32 v45, v37, v40
  v_cvt_pk_bf16_f32 v44, v44, v45
  v_and_b32 v45, 0xffff0000, v44
  v_lshlrev_b32 v44, 16, v44
  v_mul_f32 v45, v45, v43
  v_mul_f32 v44, v44, v43
  v_cvt_pk_bf16_f32 v18, v44, v45
  v_sub_f32 v44, v38, v40
  v_sub_f32 v45, v39, v40
  v_cvt_pk_bf16_f32 v44, v44, v45
  v_and_b32 v45, 0xffff0000, v44
  v_lshlrev_b32 v44, 16, v44
  v_mul_f32 v45, v45, v43
  v_mul_f32 v44, v44, v43
  v_cvt_pk_bf16_f32 v19, v44, v45
  v_lshrrev_b32 v44, 1, v3
  v_lshlrev_b32 v44, 9, v44
  v_lshl_add_u32 v44, v4, 4, v44
  v_and_b32 v45, 1, v3
  v_lshl_add_u32 v44, v45, 3, v44
  ds_write_b64 v44, v[10:11] offset:0
  ds_write_b64 v44, v[12:13] offset:256
  ds_write_b64 v44, v[14:15] offset:8192
  ds_write_b64 v44, v[16:17] offset:8448
  v_lshrrev_b32 v46, 2, v3
  v_lshlrev_b32 v46, 9, v46
  v_lshl_add_u32 v46, v4, 4, v46
  v_lshl_add_u32 v46, v45, 8, v46
  v_bfe_u32 v47, v3, 1, 1
  v_lshl_add_u32 v46, v47, 3, v46
  ds_write_b64 v46, v[18:19] offset:16384
  s_waitcnt vmcnt(0) lgkmcnt(0)
  s_barrier
  s_cmp_ge_u32 s3, 4
  s_cbranch_scc1 L_k0_copy
  v_and_b32 v9, 15, v1
  v_lshrrev_b32 v10, 4, v1
  v_lshrrev_b32 v11, 1, v10
  v_and_b32 v12, 1, v10
  v_lshlrev_b32 v13, 9, v11
  v_lshl_add_u32 v13, v12, 8, v13
  v_lshl_add_u32 v13, v9, 4, v13
  v_lshlrev_b32 v14, 4, v11
  v_lshl_add_u32 v14, v12, 2, v14
  v_lshrrev_b32 v15, 2, v9
  v_add_u32 v14, v14, v15
  v_mul_u32_u24 v14, 40, v14
  v_and_b32 v15, 3, v9
  v_lshl_add_u32 v14, v15, 3, v14
  s_lshr_b32 s20, s3, 1
  s_and_b32 s21, s3, 1
  s_mul_i32 s22, s20, 25600
  s_lshl_b32 s23, s21, 5
  s_add_u32 s22, s22, s23
  s_add_u32 s22, s22, 20480
  v_add_u32 v14, s22, v14
  v_mov_b32 v16, 0
  v_mov_b32 v17, 0
  v_mov_b32 v18, 0
  v_mov_b32 v19, 0
  s_lshr_b32 s24, s2, 1
  s_lshl_b32 s24, s24, 12
  s_add_u32 s24, s24, 5242880
  s_add_u32 s26, s12, s24
  s_addc_u32 s27, s13, 0
  s_and_b32 s25, s2, 1
  s_cmp_eq_u32 s20, 1
  s_cbranch_scc1 L_k0_v
  ds_read_b128 v[20:23], v13 offset:0
  ds_read_b64_tr_b16 v[24:25], v14 offset:0
  ds_read_b64_tr_b16 v[26:27], v14 offset:320
  ds_read_b128 v[28:31], v13 offset:1024
  ds_read_b64_tr_b16 v[32:33], v14 offset:1280
  ds_read_b64_tr_b16 v[34:35], v14 offset:1600
  ds_read_b128 v[36:39], v13 offset:2048
  ds_read_b64_tr_b16 v[40:41], v14 offset:2560
  ds_read_b64_tr_b16 v[42:43], v14 offset:2880
  ds_read_b128 v[44:47], v13 offset:3072
  ds_read_b64_tr_b16 v[48:49], v14 offset:3840
  ds_read_b64_tr_b16 v[50:51], v14 offset:4160
  s_waitcnt lgkmcnt(9)
  v_mfma_f32_16x16x32_bf16 v[16:19], v[24:27], v[20:23], v[16:19]
  s_waitcnt lgkmcnt(6)
  v_mfma_f32_16x16x32_bf16 v[16:19], v[32:35], v[28:31], v[16:19]
  s_waitcnt lgkmcnt(3)
  v_mfma_f32_16x16x32_bf16 v[16:19], v[40:43], v[36:39], v[16:19]
  s_waitcnt lgkmcnt(0)
  v_mfma_f32_16x16x32_bf16 v[16:19], v[48:51], v[44:47], v[16:19]
  ds_read_b128 v[20:23], v13 offset:4096
  ds_read_b64_tr_b16 v[24:25], v14 offset:5120
  ds_read_b64_tr_b16 v[26:27], v14 offset:5440
  ds_read_b128 v[28:31], v13 offset:5120
  ds_read_b64_tr_b16 v[32:33], v14 offset:6400
  ds_read_b64_tr_b16 v[34:35], v14 offset:6720
  ds_read_b128 v[36:39], v13 offset:6144
  ds_read_b64_tr_b16 v[40:41], v14 offset:7680
  ds_read_b64_tr_b16 v[42:43], v14 offset:8000
  ds_read_b128 v[44:47], v13 offset:7168
  ds_read_b64_tr_b16 v[48:49], v14 offset:8960
  ds_read_b64_tr_b16 v[50:51], v14 offset:9280
  s_waitcnt lgkmcnt(9)
  v_mfma_f32_16x16x32_bf16 v[16:19], v[24:27], v[20:23], v[16:19]
  s_waitcnt lgkmcnt(6)
  v_mfma_f32_16x16x32_bf16 v[16:19], v[32:35], v[28:31], v[16:19]
  s_waitcnt lgkmcnt(3)
  v_mfma_f32_16x16x32_bf16 v[16:19], v[40:43], v[36:39], v[16:19]
  s_waitcnt lgkmcnt(0)
  v_mfma_f32_16x16x32_bf16 v[16:19], v[48:51], v[44:47], v[16:19]
  ds_read_b128 v[20:23], v13 offset:8192
  ds_read_b64_tr_b16 v[24:25], v14 offset:10240
  ds_read_b64_tr_b16 v[26:27], v14 offset:10560
  ds_read_b128 v[28:31], v13 offset:9216
  ds_read_b64_tr_b16 v[32:33], v14 offset:11520
  ds_read_b64_tr_b16 v[34:35], v14 offset:11840
  ds_read_b128 v[36:39], v13 offset:10240
  ds_read_b64_tr_b16 v[40:41], v14 offset:12800
  ds_read_b64_tr_b16 v[42:43], v14 offset:13120
  ds_read_b128 v[44:47], v13 offset:11264
  ds_read_b64_tr_b16 v[48:49], v14 offset:14080
  ds_read_b64_tr_b16 v[50:51], v14 offset:14400
  s_waitcnt lgkmcnt(9)
  v_mfma_f32_16x16x32_bf16 v[16:19], v[24:27], v[20:23], v[16:19]
  s_waitcnt lgkmcnt(6)
  v_mfma_f32_16x16x32_bf16 v[16:19], v[32:35], v[28:31], v[16:19]
  s_waitcnt lgkmcnt(3)
  v_mfma_f32_16x16x32_bf16 v[16:19], v[40:43], v[36:39], v[16:19]
  s_waitcnt lgkmcnt(0)
  v_mfma_f32_16x16x32_bf16 v[16:19], v[48:51], v[44:47], v[16:19]
  ds_read_b128 v[20:23], v13 offset:12288
  ds_read_b64_tr_b16 v[24:25], v14 offset:15360
  ds_read_b64_tr_b16 v[26:27], v14 offset:15680
  ds_read_b128 v[28:31], v13 offset:13312
  ds_read_b64_tr_b16 v[32:33], v14 offset:16640
  ds_read_b64_tr_b16 v[34:35], v14 offset:16960
  ds_read_b128 v[36:39], v13 offset:14336
  ds_read_b64_tr_b16 v[40:41], v14 offset:17920
  ds_read_b64_tr_b16 v[42:43], v14 offset:18240
  ds_read_b128 v[44:47], v13 offset:15360
  ds_read_b64_tr_b16 v[48:49], v14 offset:19200
  ds_read_b64_tr_b16 v[50:51], v14 offset:19520
  s_waitcnt lgkmcnt(9)
  v_mfma_f32_16x16x32_bf16 v[16:19], v[24:27], v[20:23], v[16:19]
  s_waitcnt lgkmcnt(6)
  v_mfma_f32_16x16x32_bf16 v[16:19], v[32:35], v[28:31], v[16:19]
  s_waitcnt lgkmcnt(3)
  v_mfma_f32_16x16x32_bf16 v[16:19], v[40:43], v[36:39], v[16:19]
  s_waitcnt lgkmcnt(0)
  v_mfma_f32_16x16x32_bf16 v[16:19], v[48:51], v[44:47], v[16:19]
  ds_read_b128 v[20:23], v13 offset:16384
  ds_read_b64_tr_b16 v[24:25], v14 offset:20480
  ds_read_b64_tr_b16 v[26:27], v14 offset:20800
  ds_read_b128 v[28:31], v13 offset:17408
  ds_read_b64_tr_b16 v[32:33], v14 offset:21760
  ds_read_b64_tr_b16 v[34:35], v14 offset:22080
  ds_read_b128 v[36:39], v13 offset:18432
  ds_read_b64_tr_b16 v[40:41], v14 offset:23040
  ds_read_b64_tr_b16 v[42:43], v14 offset:23360
  ds_read_b128 v[44:47], v13 offset:19456
  ds_read_b64_tr_b16 v[48:49], v14 offset:24320
  ds_read_b64_tr_b16 v[50:51], v14 offset:24640
  s_waitcnt lgkmcnt(9)
  v_mfma_f32_16x16x32_bf16 v[16:19], v[24:27], v[20:23], v[16:19]
  s_waitcnt lgkmcnt(6)
  v_mfma_f32_16x16x32_bf16 v[16:19], v[32:35], v[28:31], v[16:19]
  s_waitcnt lgkmcnt(3)
  v_mfma_f32_16x16x32_bf16 v[16:19], v[40:43], v[36:39], v[16:19]
  s_waitcnt lgkmcnt(0)
  v_mfma_f32_16x16x32_bf16 v[16:19], v[48:51], v[44:47], v[16:19]
  s_nop 7
  s_nop 1
  v_cvt_pk_bf16_f32 v20, v16, v17
  v_cvt_pk_bf16_f32 v21, v18, v19
  s_mov_b32 s28, 0x3ea52b5c
  v_lshlrev_b32 v16, 16, v20
  v_and_b32 v17, 0xffff0000, v20
  v_lshlrev_b32 v18, 16, v21
  v_and_b32 v19, 0xffff0000, v21
  v_mul_f32 v16, s28, v16
  v_mul_f32 v17, s28, v17
  v_mul_f32 v18, s28, v18
  v_mul_f32 v19, s28, v19
  v_cvt_pk_bf16_f32 v20, v16, v17
  v_cvt_pk_bf16_f32 v21, v18, v19
  s_lshl_b32 s29, s25, 4
  v_add_u32 v22, s29, v9
  s_cmp_eq_u32 s21, 1
  s_cbranch_scc1 L_k0_k2
  v_lshl_add_u32 v23, v12, 5, v22
  v_lshlrev_b32 v23, 4, v23
  v_lshl_add_u32 v23, v11, 3, v23
  global_store_dwordx2 v23, v[20:21], s[26:27]
  s_branch L_k0_fin
L_k0_k2:
  v_cmp_eq_u32 vcc, 1, v10
  v_mov_b32 v24, 0x3f803f80
  v_mov_b32 v25, 0x3f80
  v_cndmask_b32 v20, v20, v24, vcc
  v_cndmask_b32 v21, v21, v25, vcc
  v_lshl_add_u32 v23, v10, 5, v22
  v_lshlrev_b32 v23, 4, v23
  s_mov_b64 exec, 0xffffffff
  global_store_dwordx2 v23, v[20:21], s[26:27] offset:3072
  s_branch L_k0_fin
L_k0_v:
  ds_read_b128 v[20:23], v13 offset:0
  ds_read_b64_tr_b16 v[24:25], v14 offset:0
  ds_read_b64_tr_b16 v[26:27], v14 offset:320
  ds_read_b128 v[28:31], v13 offset:1024
  ds_read_b64_tr_b16 v[32:33], v14 offset:1280
  ds_read_b64_tr_b16 v[34:35], v14 offset:1600
  ds_read_b128 v[36:39], v13 offset:2048
  ds_read_b64_tr_b16 v[40:41], v14 offset:2560
  ds_read_b64_tr_b16 v[42:43], v14 offset:2880
  ds_read_b128 v[44:47], v13 offset:3072
  ds_read_b64_tr_b16 v[48:49], v14 offset:3840
  ds_read_b64_tr_b16 v[50:51], v14 offset:4160
  s_waitcnt lgkmcnt(9)
  v_mfma_f32_16x16x32_bf16 v[16:19], v[20:23], v[24:27], v[16:19]
  s_waitcnt lgkmcnt(6)
  v_mfma_f32_16x16x32_bf16 v[16:19], v[28:31], v[32:35], v[16:19]
  s_waitcnt lgkmcnt(3)
  v_mfma_f32_16x16x32_bf16 v[16:19], v[36:39], v[40:43], v[16:19]
  s_waitcnt lgkmcnt(0)
  v_mfma_f32_16x16x32_bf16 v[16:19], v[44:47], v[48:51], v[16:19]
  ds_read_b128 v[20:23], v13 offset:4096
  ds_read_b64_tr_b16 v[24:25], v14 offset:5120
  ds_read_b64_tr_b16 v[26:27], v14 offset:5440
  ds_read_b128 v[28:31], v13 offset:5120
  ds_read_b64_tr_b16 v[32:33], v14 offset:6400
  ds_read_b64_tr_b16 v[34:35], v14 offset:6720
  ds_read_b128 v[36:39], v13 offset:6144
  ds_read_b64_tr_b16 v[40:41], v14 offset:7680
  ds_read_b64_tr_b16 v[42:43], v14 offset:8000
  ds_read_b128 v[44:47], v13 offset:7168
  ds_read_b64_tr_b16 v[48:49], v14 offset:8960
  ds_read_b64_tr_b16 v[50:51], v14 offset:9280
  s_waitcnt lgkmcnt(9)
  v_mfma_f32_16x16x32_bf16 v[16:19], v[20:23], v[24:27], v[16:19]
  s_waitcnt lgkmcnt(6)
  v_mfma_f32_16x16x32_bf16 v[16:19], v[28:31], v[32:35], v[16:19]
  s_waitcnt lgkmcnt(3)
  v_mfma_f32_16x16x32_bf16 v[16:19], v[36:39], v[40:43], v[16:19]
  s_waitcnt lgkmcnt(0)
  v_mfma_f32_16x16x32_bf16 v[16:19], v[44:47], v[48:51], v[16:19]
  ds_read_b128 v[20:23], v13 offset:8192
  ds_read_b64_tr_b16 v[24:25], v14 offset:10240
  ds_read_b64_tr_b16 v[26:27], v14 offset:10560
  ds_read_b128 v[28:31], v13 offset:9216
  ds_read_b64_tr_b16 v[32:33], v14 offset:11520
  ds_read_b64_tr_b16 v[34:35], v14 offset:11840
  ds_read_b128 v[36:39], v13 offset:10240
  ds_read_b64_tr_b16 v[40:41], v14 offset:12800
  ds_read_b64_tr_b16 v[42:43], v14 offset:13120
  ds_read_b128 v[44:47], v13 offset:11264
  ds_read_b64_tr_b16 v[48:49], v14 offset:14080
  ds_read_b64_tr_b16 v[50:51], v14 offset:14400
  s_waitcnt lgkmcnt(9)
  v_mfma_f32_16x16x32_bf16 v[16:19], v[20:23], v[24:27], v[16:19]
  s_waitcnt lgkmcnt(6)
  v_mfma_f32_16x16x32_bf16 v[16:19], v[28:31], v[32:35], v[16:19]
  s_waitcnt lgkmcnt(3)
  v_mfma_f32_16x16x32_bf16 v[16:19], v[36:39], v[40:43], v[16:19]
  s_waitcnt lgkmcnt(0)
  v_mfma_f32_16x16x32_bf16 v[16:19], v[44:47], v[48:51], v[16:19]
  ds_read_b128 v[20:23], v13 offset:12288
  ds_read_b64_tr_b16 v[24:25], v14 offset:15360
  ds_read_b64_tr_b16 v[26:27], v14 offset:15680
  ds_read_b128 v[28:31], v13 offset:13312
  ds_read_b64_tr_b16 v[32:33], v14 offset:16640
  ds_read_b64_tr_b16 v[34:35], v14 offset:16960
  ds_read_b128 v[36:39], v13 offset:14336
  ds_read_b64_tr_b16 v[40:41], v14 offset:17920
  ds_read_b64_tr_b16 v[42:43], v14 offset:18240
  ds_read_b128 v[44:47], v13 offset:15360
  ds_read_b64_tr_b16 v[48:49], v14 offset:19200
  ds_read_b64_tr_b16 v[50:51], v14 offset:19520
  s_waitcnt lgkmcnt(9)
  v_mfma_f32_16x16x32_bf16 v[16:19], v[20:23], v[24:27], v[16:19]
  s_waitcnt lgkmcnt(6)
  v_mfma_f32_16x16x32_bf16 v[16:19], v[28:31], v[32:35], v[16:19]
  s_waitcnt lgkmcnt(3)
  v_mfma_f32_16x16x32_bf16 v[16:19], v[36:39], v[40:43], v[16:19]
  s_waitcnt lgkmcnt(0)
  v_mfma_f32_16x16x32_bf16 v[16:19], v[44:47], v[48:51], v[16:19]
  ds_read_b128 v[20:23], v13 offset:16384
  ds_read_b64_tr_b16 v[24:25], v14 offset:20480
  ds_read_b64_tr_b16 v[26:27], v14 offset:20800
  ds_read_b128 v[28:31], v13 offset:17408
  ds_read_b64_tr_b16 v[32:33], v14 offset:21760
  ds_read_b64_tr_b16 v[34:35], v14 offset:22080
  ds_read_b128 v[36:39], v13 offset:18432
  ds_read_b64_tr_b16 v[40:41], v14 offset:23040
  ds_read_b64_tr_b16 v[42:43], v14 offset:23360
  ds_read_b128 v[44:47], v13 offset:19456
  ds_read_b64_tr_b16 v[48:49], v14 offset:24320
  ds_read_b64_tr_b16 v[50:51], v14 offset:24640
  s_waitcnt lgkmcnt(9)
  v_mfma_f32_16x16x32_bf16 v[16:19], v[20:23], v[24:27], v[16:19]
  s_waitcnt lgkmcnt(6)
  v_mfma_f32_16x16x32_bf16 v[16:19], v[28:31], v[32:35], v[16:19]
  s_waitcnt lgkmcnt(3)
  v_mfma_f32_16x16x32_bf16 v[16:19], v[36:39], v[40:43], v[16:19]
  s_waitcnt lgkmcnt(0)
  v_mfma_f32_16x16x32_bf16 v[16:19], v[44:47], v[48:51], v[16:19]
  s_nop 7
  s_nop 1
  v_cvt_pk_bf16_f32 v20, v16, v17
  v_cvt_pk_bf16_f32 v21, v18, v19
  s_lshl_b32 s29, s21, 4
  v_add_u32 v22, s29, v9
  v_cmp_le_u32 vcc, 20, v22
  s_nop 1
  v_cndmask_b32 v20, v20, 0, vcc
  v_cndmask_b32 v21, v21, 0, vcc
  v_and_b32 v24, 0x1b, v22
  v_cmp_eq_u32 vcc, 24, v24
  v_mov_b32 v24, 0x3f803f80
  s_nop 0
  v_cndmask_b32 v20, v20, v24, vcc
  v_cndmask_b32 v21, v21, v24, vcc
  v_lshl_add_u32 v23, v12, 5, v22
  v_lshlrev_b32 v23, 4, v23
  v_lshl_add_u32 v23, v11, 3, v23
  s_lshl_b32 s29, s25, 10
  v_add_u32 v23, s29, v23
  global_store_dwordx2 v23, v[20:21], s[26:27] offset:1024
  s_branch L_k0_fin
L_k0_copy:
  s_sub_u32 s20, s3, 4
  s_mul_i32 s20, s20, 5120
  v_add_u32 v9, s20, v8
  ds_read_b128 v[20:23], v9 offset:0
  ds_read_b128 v[24:27], v9 offset:1024
  ds_read_b128 v[28:31], v9 offset:2048
  ds_read_b128 v[32:35], v9 offset:3072
  ds_read_b128 v[36:39], v9 offset:4096
  s_lshr_b32 s21, s2, 1
  s_mul_i32 s21, s21, 40960
  s_and_b32 s22, s2, 1
  s_lshl_b32 s22, s22, 8
  s_add_u32 s21, s21, s22
  s_add_u32 s21, s21, 0
  s_add_u32 s24, s12, s21
  s_addc_u32 s25, s13, 0
  v_and_b32 v10, 0xff, v9
  v_lshrrev_b32 v11, 8, v9
  v_lshl_add_u32 v10, v11, 9, v10
  s_waitcnt lgkmcnt(4)
  global_store_dwordx4 v10, v[20:23], s[24:25] offset:0
  s_waitcnt lgkmcnt(3)
  global_store_dwordx4 v10, v[24:27], s[24:25] offset:2048
  s_waitcnt lgkmcnt(2)
  v_add_u32 v12, 4096, v10
  global_store_dwordx4 v12, v[28:31], s[24:25]
  s_waitcnt lgkmcnt(1)
  v_add_u32 v13, 6144, v10
  global_store_dwordx4 v13, v[32:35], s[24:25]
  s_waitcnt lgkmcnt(0)
  v_add_u32 v14, 8192, v10
  global_store_dwordx4 v14, v[36:39], s[24:25]
  s_branch L_k0_fin
L_k0_pack:
  s_load_dwordx2 s[4:5], s[0:1], 8
  s_load_dwordx2 s[6:7], s[0:1], 32
  s_load_dwordx4 s[8:11], s[0:1], 48
  s_load_dwordx2 s[14:15], s[0:1], 64
  s_load_dwordx2 s[12:13], s[0:1], 88
  v_and_b32 v1, 63, v0
  v_lshrrev_b32 v2, 6, v0
  s_nop 0
  v_readfirstlane_b32 s3, v2
  s_sub_u32 s16, s2, 128
  s_lshl_b32 s16, s16, 1
  s_lshr_b32 s17, s3, 2
  s_add_u32 s16, s16, s17
  s_lshl_b32 s33, s17, 14
  s_and_b32 s3, s3, 3
  s_lshr_b32 s19, s3, 1
  v_lshrrev_b32 v2, 5, v1
  v_bfe_u32 v3, v1, 2, 2
  v_lshl_add_u32 v4, v2, 2, v3
  v_bfe_u32 v5, v1, 4, 1
  v_and_b32 v6, 3, v1
  v_lshlrev_b32 v7, 6, v5
  v_lshl_add_u32 v7, v6, 4, v7
  v_lshlrev_b32 v14, 4, v1
  s_waitcnt lgkmcnt(0)
  s_cmp_lt_u32 s16, 270
  s_cbranch_scc1 L_pk_gu
  s_cmp_lt_u32 s16, 455
  s_cbranch_scc1 L_pk_od
  s_cmp_lt_u32 s16, 535
  s_cbranch_scc1 L_pk_wq
  s_barrier
  s_branch L_k0_fin
L_pk_gu:
  s_mul_i32 s17, s16, 6554
  s_lshr_b32 s17, s17, 16
  s_mul_i32 s18, s17, 10
  s_sub_u32 s18, s16, s18
  s_cmp_eq_u32 s19, 0
  s_cselect_b32 s20, s8, s10
  s_cselect_b32 s21, s9, s11
  s_mul_i32 s22, s18, 221184
  s_lshl_b32 s23, s17, 7
  s_add_u32 s22, s22, s23
  s_add_u32 s20, s20, s22
  s_addc_u32 s21, s21, 0
  v_mul_u32_u24 v8, 3456, v4
  v_add_u32 v8, v8, v7
  s_and_b32 s24, s3, 1
  s_mul_i32 s24, s24, 110592
  s_add_u32 s20, s20, s24
  s_addc_u32 s21, s21, 0
  s_lshl_b32 s27, s3, 12
  s_add_u32 s27, s27, s33
  s_add_u32 m0, s27, 0
  s_nop 0
  global_load_lds_dwordx4 v8, s[20:21]
  s_add_u32 s20, s20, 27648
  s_addc_u32 s21, s21, 0
  s_add_u32 m0, s27, 1024
  s_nop 0
  global_load_lds_dwordx4 v8, s[20:21]
  s_add_u32 s20, s20, 27648
  s_addc_u32 s21, s21, 0
  s_add_u32 m0, s27, 2048
  s_nop 0
  global_load_lds_dwordx4 v8, s[20:21]
  s_add_u32 s20, s20, 27648
  s_addc_u32 s21, s21, 0
  s_add_u32 m0, s27, 3072
  s_nop 0
  global_load_lds_dwordx4 v8, s[20:21]
  v_lshlrev_b32 v9, 9, v2
  v_lshl_add_u32 v9, v3, 6, v9
  v_lshl_add_u32 v9, v5, 5, v9
  v_lshl_add_u32 v9, v6, 3, v9
  v_add_u32 v9, s33, v9
  s_lshl_b32 s22, s3, 11
  v_add_u32 v9, s22, v9
  s_mul_i32 s22, s17, 40
  s_lshl_b32 s23, s18, 2
  s_add_u32 s22, s22, s23
  s_add_u32 s22, s22, s3
  s_lshl_b32 s22, s22, 12
  s_add_u32 s22, s22, 16580608
  s_add_u32 s28, s12, s22
  s_addc_u32 s29, s13, 0
  s_waitcnt vmcnt(0)
  s_barrier
  ds_read_b64_tr_b16 v[20:21], v9 offset:0
  ds_read_b64_tr_b16 v[22:23], v9 offset:1024
  ds_read_b64_tr_b16 v[24:25], v9 offset:256
  ds_read_b64_tr_b16 v[26:27], v9 offset:1280
  ds_read_b64_tr_b16 v[28:29], v9 offset:8192
  ds_read_b64_tr_b16 v[30:31], v9 offset:9216
  ds_read_b64_tr_b16 v[32:33], v9 offset:8448
  ds_read_b64_tr_b16 v[34:35], v9 offset:9472
  s_waitcnt lgkmcnt(6)
  global_store_dwordx4 v14, v[20:23], s[28:29] offset:0
  s_waitcnt lgkmcnt(4)
  global_store_dwordx4 v14, v[24:27], s[28:29] offset:1024
  s_waitcnt lgkmcnt(2)
  global_store_dwordx4 v14, v[28:31], s[28:29] offset:2048
  s_waitcnt lgkmcnt(0)
  global_store_dwordx4 v14, v[32:35], s[28:29] offset:3072
  s_branch L_k0_fin
L_pk_od:
  s_sub_u32 s16, s16, 270
  s_mul_i32 s17, s16, 13108
  s_lshr_b32 s17, s17, 16
  s_mul_i32 s18, s17, 5
  s_sub_u32 s18, s16, s18
  s_sub_u32 s22, s17, 10
  s_add_u32 s23, s17, 27
  s_cmp_lt_u32 s17, 10
  s_cselect_b32 s20, s6, s14
  s_cselect_b32 s21, s7, s15
  s_cselect_b32 s22, s17, s22
  s_cselect_b32 s30, s23, s22
  s_mul_i32 s22, s22, 81920
  s_lshl_b32 s23, s18, 8
  s_add_u32 s22, s22, s23
  s_lshl_b32 s23, s19, 7
  s_add_u32 s22, s22, s23
  s_add_u32 s20, s20, s22
  s_addc_u32 s21, s21, 0
  v_mul_u32_u24 v8, 1280, v4
  v_add_u32 v8, v8, v7
  s_and_b32 s24, s3, 1
  s_mul_i32 s24, s24, 40960
  s_add_u32 s20, s20, s24
  s_addc_u32 s21, s21, 0
  s_lshl_b32 s27, s3, 12
  s_add_u32 s27, s27, s33
  s_add_u32 m0, s27, 0
  s_nop 0
  global_load_lds_dwordx4 v8, s[20:21]
  s_add_u32 s20, s20, 10240
  s_addc_u32 s21, s21, 0
  s_add_u32 m0, s27, 1024
  s_nop 0
  global_load_lds_dwordx4 v8, s[20:21]
  s_add_u32 s20, s20, 10240
  s_addc_u32 s21, s21, 0
  s_add_u32 m0, s27, 2048
  s_nop 0
  global_load_lds_dwordx4 v8, s[20:21]
  s_add_u32 s20, s20, 10240
  s_addc_u32 s21, s21, 0
  s_add_u32 m0, s27, 3072
  s_nop 0
  global_load_lds_dwordx4 v8, s[20:21]
  v_lshlrev_b32 v9, 11, v2
  v_lshl_add_u32 v9, v5, 9, v9
  v_lshl_add_u32 v9, v3, 6, v9
  v_lshl_add_u32 v9, v6, 3, v9
  s_lshl_b32 s22, s19, 12
  s_and_b32 s23, s3, 1
  s_lshl_b32 s24, s23, 13
  s_add_u32 s22, s22, s24
  s_add_u32 s22, s22, s33
  v_add_u32 v9, s22, v9
  s_lshl_b32 s24, s18, 3
  s_lshl_b32 s23, s23, 2
  s_add_u32 s24, s24, s23
  s_lshl_b32 s30, s30, 1
  s_add_u32 s30, s30, s19
  s_add_u32 s25, s24, 0
  s_mul_i32 s26, s25, 205
  s_lshr_b32 s26, s26, 10
  s_mul_i32 s27, s26, 5
  s_sub_u32 s27, s25, s27
  s_mul_i32 s26, s26, 74
  s_add_u32 s26, s26, s30
  s_mul_i32 s26, s26, 5
  s_add_u32 s26, s26, s27
  s_lshl_b32 s26, s26, 10
  s_add_u32 s26, s26, 21004288
  v_add_u32 v10, s26, v14
  s_add_u32 s25, s24, 1
  s_mul_i32 s26, s25, 205
  s_lshr_b32 s26, s26, 10
  s_mul_i32 s27, s26, 5
  s_sub_u32 s27, s25, s27
  s_mul_i32 s26, s26, 74
  s_add_u32 s26, s26, s30
  s_mul_i32 s26, s26, 5
  s_add_u32 s26, s26, s27
  s_lshl_b32 s26, s26, 10
  s_add_u32 s26, s26, 21004288
  v_add_u32 v11, s26, v14
  s_add_u32 s25, s24, 2
  s_mul_i32 s26, s25, 205
  s_lshr_b32 s26, s26, 10
  s_mul_i32 s27, s26, 5
  s_sub_u32 s27, s25, s27
  s_mul_i32 s26, s26, 74
  s_add_u32 s26, s26, s30
  s_mul_i32 s26, s26, 5
  s_add_u32 s26, s26, s27
  s_lshl_b32 s26, s26, 10
  s_add_u32 s26, s26, 21004288
  v_add_u32 v12, s26, v14
  s_add_u32 s25, s24, 3
  s_mul_i32 s26, s25, 205
  s_lshr_b32 s26, s26, 10
  s_mul_i32 s27, s26, 5
  s_sub_u32 s27, s25, s27
  s_mul_i32 s26, s26, 74
  s_add_u32 s26, s26, s30
  s_mul_i32 s26, s26, 5
  s_add_u32 s26, s26, s27
  s_lshl_b32 s26, s26, 10
  s_add_u32 s26, s26, 21004288
  v_add_u32 v13, s26, v14
  s_waitcnt vmcnt(0)
  s_barrier
  ds_read_b64_tr_b16 v[20:21], v9 offset:0
  ds_read_b64_tr_b16 v[22:23], v9 offset:1024
  ds_read_b64_tr_b16 v[24:25], v9 offset:32
  ds_read_b64_tr_b16 v[26:27], v9 offset:1056
  ds_read_b64_tr_b16 v[28:29], v9 offset:256
  ds_read_b64_tr_b16 v[30:31], v9 offset:1280
  ds_read_b64_tr_b16 v[32:33], v9 offset:288
  ds_read_b64_tr_b16 v[34:35], v9 offset:1312
  s_waitcnt lgkmcnt(6)
  global_store_dwordx4 v10, v[20:23], s[12:13]
  s_waitcnt lgkmcnt(4)
  global_store_dwordx4 v11, v[24:27], s[12:13]
  s_waitcnt lgkmcnt(2)
  global_store_dwordx4 v12, v[28:31], s[12:13]
  s_waitcnt lgkmcnt(0)
  global_store_dwordx4 v13, v[32:35], s[12:13]
  s_branch L_k0_fin
L_pk_wq:
  s_sub_u32 s16, s16, 455
  s_lshr_b32 s17, s16, 3
  s_and_b32 s18, s16, 7
  s_mul_i32 s22, s17, 81920
  s_mul_i32 s23, s18, 160
  s_add_u32 s22, s22, s23
  s_lshl_b32 s23, s19, 7
  s_add_u32 s22, s22, s23
  s_add_u32 s20, s4, s22
  s_addc_u32 s21, s5, 0
  s_cmp_eq_u32 s19, 0
  s_cselect_b32 s23, 112, 16
  v_min_u32 v7, s23, v7
  v_mul_u32_u24 v8, 1280, v4
  v_add_u32 v8, v8, v7
  s_and_b32 s24, s3, 1
  s_mul_i32 s24, s24, 40960
  s_add_u32 s20, s20, s24
  s_addc_u32 s21, s21, 0
  s_lshl_b32 s27, s3, 12
  s_add_u32 s27, s27, s33
  s_add_u32 m0, s27, 0
  s_nop 0
  global_load_lds_dwordx4 v8, s[20:21]
  s_add_u32 s20, s20, 10240
  s_addc_u32 s21, s21, 0
  s_add_u32 m0, s27, 1024
  s_nop 0
  global_load_lds_dwordx4 v8, s[20:21]
  s_add_u32 s20, s20, 10240
  s_addc_u32 s21, s21, 0
  s_add_u32 m0, s27, 2048
  s_nop 0
  global_load_lds_dwordx4 v8, s[20:21]
  s_add_u32 s20, s20, 10240
  s_addc_u32 s21, s21, 0
  s_add_u32 m0, s27, 3072
  s_nop 0
  global_load_lds_dwordx4 v8, s[20:21]
  s_mul_i32 s22, s3, 20
  v_lshlrev_b32 v9, 4, v5
  v_lshl_add_u32 v9, v6, 2, v9
  v_add_u32 v9, s22, v9
  v_lshrrev_b32 v10, 6, v9
  v_lshlrev_b32 v10, 13, v10
  v_bfe_u32 v11, v9, 5, 1
  v_lshl_add_u32 v10, v11, 8, v10
  v_and_b32 v11, 31, v9
  v_lshl_add_u32 v10, v11, 1, v10
  v_lshl_add_u32 v10, v2, 9, v10
  v_lshl_add_u32 v10, v3, 6, v10
  v_add_u32 v9, s33, v10
  s_lshl_b32 s22, s18, 2
  s_add_u32 s22, s22, s3
  s_mul_i32 s22, s22, 40
  s_lshl_b32 s23, s17, 2
  s_add_u32 s22, s22, s23
  s_lshl_b32 s22, s22, 10
  s_add_u32 s22, s22, 15269888
  s_add_u32 s28, s12, s22
  s_addc_u32 s29, s13, 0
  v_and_b32 v10, 31, v1
  v_cmp_le_u32 vcc, 20, v10
  s_waitcnt vmcnt(0)
  s_barrier
  ds_read_b64_tr_b16 v[20:21], v9 offset:0
  ds_read_b64_tr_b16 v[22:23], v9 offset:1024
  ds_read_b64_tr_b16 v[24:25], v9 offset:2048
  ds_read_b64_tr_b16 v[26:27], v9 offset:3072
  ds_read_b64_tr_b16 v[28:29], v9 offset:4096
  ds_read_b64_tr_b16 v[30:31], v9 offset:5120
  ds_read_b64_tr_b16 v[32:33], v9 offset:6144
  ds_read_b64_tr_b16 v[34:35], v9 offset:7168
  s_waitcnt lgkmcnt(6)
  v_cndmask_b32 v20, v20, 0, vcc
  v_cndmask_b32 v21, v21, 0, vcc
  v_cndmask_b32 v22, v22, 0, vcc
  v_cndmask_b32 v23, v23, 0, vcc
  global_store_dwordx4 v14, v[20:23], s[28:29] offset:0
  s_waitcnt lgkmcnt(4)
  v_cndmask_b32 v24, v24, 0, vcc
  v_cndmask_b32 v25, v25, 0, vcc
  v_cndmask_b32 v26, v26, 0, vcc
  v_cndmask_b32 v27, v27, 0, vcc
  global_store_dwordx4 v14, v[24:27], s[28:29] offset:1024
  s_waitcnt lgkmcnt(2)
  v_cndmask_b32 v28, v28, 0, vcc
  v_cndmask_b32 v29, v29, 0, vcc
  v_cndmask_b32 v30, v30, 0, vcc
  v_cndmask_b32 v31, v31, 0, vcc
  global_store_dwordx4 v14, v[28:31], s[28:29] offset:2048
  s_waitcnt lgkmcnt(0)
  v_cndmask_b32 v32, v32, 0, vcc
  v_cndmask_b32 v33, v33, 0, vcc
  v_cndmask_b32 v34, v34, 0, vcc
  v_cndmask_b32 v35, v35, 0, vcc
  global_store_dwordx4 v14, v[32:35], s[28:29] offset:3072
  s_branch L_k0_fin
L_k0_fin:
L_k0_ln_kv_kernel_end:
  s_endpgm
.globl kf_attgu_kernel
.p2align 8
.type kf_attgu_kernel,@function
kf_attgu_kernel:
  s_cmp_ge_u32 s2, 512
  s_cbranch_scc1 L_kf_attgu_kernel_end
  s_cmp_ge_u32 s2, 256
  s_cbranch_scc1 L_role_gu
  s_setprio 3
  s_load_dwordx2 s[12:13], s[0:1], 88
  s_load_dwordx2 s[44:45], s[0:1], 80
  v_and_b32 v1, 63, v0
  v_lshrrev_b32 v2, 6, v0
  v_and_b32 v3, 31, v0
  v_readfirstlane_b32 s3, v2
  v_bfe_u32 v4, v0, 5, 1
  s_and_b32 s14, s2, 7
  s_lshr_b32 s15, s2, 3
  s_lshl_b32 s16, s14, 2
  s_add_u32 s16, s16, s3
  v_lshlrev_b32 v1, 4, v1
  s_mul_i32 s18, s16, 40960
  s_add_u32 s18, s18, 15269888
  s_lshl_b32 s19, s15, 1
  s_lshr_b32 s20, s3, 1
  s_add_u32 s19, s19, s20
  s_mul_i32 s19, s19, 40960
  s_and_b32 s20, s3, 1
  s_lshl_b32 s20, s20, 12
  s_add_u32 s19, s19, s20
  s_add_u32 s19, s19, 0
  s_lshl_b32 s38, s3, 12
  s_waitcnt lgkmcnt(0)
  s_add_u32 s24, s12, s18
  s_addc_u32 s25, s13, 0
  s_add_u32 s26, s12, s19
  s_addc_u32 s27, s13, 0
  s_add_u32 s30, s12, 5242880
  s_addc_u32 s31, s13, 0
  s_mov_b32 s32, s30
  s_mov_b32 s33, s31
  s_add_u32 m0, s38, 0
  s_nop 0
  global_load_lds_dwordx4 v1, s[26:27] offset:0
  global_load_lds_dwordx4 v1, s[26:27] offset:1024
  global_load_lds_dwordx4 v1, s[26:27] offset:2048
  global_load_lds_dwordx4 v1, s[26:27] offset:3072
  s_add_u32 s26, s26, 8192
  s_addc_u32 s27, s27, 0
  global_load_dwordx4 v[64:67], v1, s[24:25] offset:0
  global_load_dwordx4 v[68:71], v1, s[24:25] offset:1024
  global_load_dwordx4 v[72:75], v1, s[24:25] offset:2048
  global_load_dwordx4 v[76:79], v1, s[24:25] offset:3072
  s_add_u32 s24, s24, 4096
  s_addc_u32 s25, s25, 0
  global_load_dwordx4 v[80:83], v1, s[24:25] offset:0
  global_load_dwordx4 v[84:87], v1, s[24:25] offset:1024
  global_load_dwordx4 v[88:91], v1, s[24:25] offset:2048
  s_add_u32 m0, s38, 16384
  s_nop 0
  global_load_lds_dwordx4 v1, s[26:27] offset:0
  global_load_lds_dwordx4 v1, s[26:27] offset:1024
  global_load_lds_dwordx4 v1, s[26:27] offset:2048
  global_load_lds_dwordx4 v1, s[26:27] offset:3072
  s_add_u32 s26, s26, 8192
  s_addc_u32 s27, s27, 0
  s_add_u32 m0, s38, 32768
  s_nop 0
  global_load_lds_dwordx4 v1, s[26:27] offset:0
  global_load_lds_dwordx4 v1, s[26:27] offset:1024
  global_load_lds_dwordx4 v1, s[26:27] offset:2048
  global_load_lds_dwordx4 v1, s[26:27] offset:3072
  s_add_u32 s26, s26, 8192
  s_addc_u32 s27, s27, 0
  s_mul_i32 s17, s16, 5
  s_add_u32 s18, s17, 0
  s_lshr_b32 s19, s18, 2
  s_lshl_b32 s48, s19, 10
  s_and_b32 s19, s18, 1
  s_lshl_b32 s19, s19, 9
  s_add_u32 s48, s48, s19
  s_bfe_u32 s19, s18, 0x10001
  s_lshl_b32 s19, s19, 3
  s_add_u32 s48, s48, s19
  s_add_u32 s18, s17, 1
  s_lshr_b32 s19, s18, 2
  s_lshl_b32 s49, s19, 10
  s_and_b32 s19, s18, 1
  s_lshl_b32 s19, s19, 9
  s_add_u32 s49, s49, s19
  s_bfe_u32 s19, s18, 0x10001
  s_lshl_b32 s19, s19, 3
  s_add_u32 s49, s49, s19
  s_add_u32 s18, s17, 2
  s_lshr_b32 s19, s18, 2
  s_lshl_b32 s50, s19, 10
  s_and_b32 s19, s18, 1
  s_lshl_b32 s19, s19, 9
  s_add_u32 s50, s50, s19
  s_bfe_u32 s19, s18, 0x10001
  s_lshl_b32 s19, s19, 3
  s_add_u32 s50, s50, s19
  s_add_u32 s18, s17, 3
  s_lshr_b32 s19, s18, 2
  s_lshl_b32 s51, s19, 10
  s_and_b32 s19, s18, 1
  s_lshl_b32 s19, s19, 9
  s_add_u32 s51, s51, s19
  s_bfe_u32 s19, s18, 0x10001
  s_lshl_b32 s19, s19, 3
  s_add_u32 s51, s51, s19
  s_add_u32 s18, s17, 4
  s_lshr_b32 s19, s18, 2
  s_lshl_b32 s52, s19, 10
  s_and_b32 s19, s18, 1
  s_lshl_b32 s19, s19, 9
  s_add_u32 s52, s52, s19
  s_bfe_u32 s19, s18, 0x10001
  s_lshl_b32 s19, s19, 3
  s_add_u32 s52, s52, s19
  v_lshlrev_b32 v3, 4, v3
  s_sub_u32 s18, s49, s48
  v_mul_i32_i24 v5, s18, v4
  v_add3_u32 v5, v5, v3, s48
  s_sub_u32 s18, s51, s50
  v_mul_i32_i24 v6, s18, v4
  v_add3_u32 v6, v6, v3, s50
  v_add_u32 v7, s52, v3
  v_add_u32 v2, 4096, v1
  v_add_u32 v3, 8192, v1
  v_add_u32 v24, 12288, v1
  v_add_u32 v25, 16384, v1
  v_add_u32 v26, 20480, v1
  v_add_u32 v27, 24576, v1
  s_waitcnt vmcnt(15)
  s_barrier
  ds_read_b128 v[96:99], v1 offset:0
  ds_read_b128 v[100:103], v1 offset:8192
  ds_read_b128 v[104:107], v1 offset:1024
  ds_read_b128 v[108:111], v1 offset:9216
  global_load_dwordx4 v[92:95], v1, s[24:25] offset:3072
  s_add_u32 s24, s24, 4096
  s_addc_u32 s25, s25, 0
  s_waitcnt vmcnt(15) lgkmcnt(2)
  v_mfma_f32_32x32x16_bf16 v[32:47], v[64:67], v[96:99], 0
  v_mfma_f32_32x32x16_bf16 v[48:63], v[64:67], v[100:103], 0
  ds_read_b128 v[96:99], v1 offset:2048
  ds_read_b128 v[100:103], v1 offset:10240
  global_load_dwordx4 v[64:67], v1, s[24:25] offset:0
  s_waitcnt vmcnt(15) lgkmcnt(2)
  v_mfma_f32_32x32x16_bf16 v[32:47], v[68:71], v[104:107], v[32:47]
  v_mfma_f32_32x32x16_bf16 v[48:63], v[68:71], v[108:111], v[48:63]
  ds_read_b128 v[104:107], v1 offset:3072
  ds_read_b128 v[108:111], v1 offset:11264
  global_load_dwordx4 v[68:71], v1, s[24:25] offset:1024
  s_waitcnt vmcnt(15) lgkmcnt(2)
  v_mfma_f32_32x32x16_bf16 v[32:47], v[72:75], v[96:99], v[32:47]
  v_mfma_f32_32x32x16_bf16 v[48:63], v[72:75], v[100:103], v[48:63]
  ds_read_b128 v[96:99], v1 offset:4096
  ds_read_b128 v[100:103], v1 offset:12288
  global_load_dwordx4 v[72:75], v1, s[24:25] offset:2048
  s_waitcnt vmcnt(15) lgkmcnt(2)
  v_mfma_f32_32x32x16_bf16 v[32:47], v[76:79], v[104:107], v[32:47]
  v_mfma_f32_32x32x16_bf16 v[48:63], v[76:79], v[108:111], v[48:63]
  ds_read_b128 v[104:107], v1 offset:5120
  ds_read_b128 v[108:111], v1 offset:13312
  global_load_dwordx4 v[76:79], v1, s[24:25] offset:3072
  s_add_u32 s24, s24, 4096
  s_addc_u32 s25, s25, 0
  s_waitcnt vmcnt(15) lgkmcnt(2)
  v_mfma_f32_32x32x16_bf16 v[32:47], v[80:83], v[96:99], v[32:47]
  v_mfma_f32_32x32x16_bf16 v[48:63], v[80:83], v[100:103], v[48:63]
  ds_read_b128 v[96:99], v1 offset:6144
  ds_read_b128 v[100:103], v1 offset:14336
  global_load_dwordx4 v[80:83], v1, s[24:25] offset:0
  s_waitcnt vmcnt(15) lgkmcnt(2)
  v_mfma_f32_32x32x16_bf16 v[32:47], v[84:87], v[104:107], v[32:47]
  v_mfma_f32_32x32x16_bf16 v[48:63], v[84:87], v[108:111], v[48:63]
  ds_read_b128 v[104:107], v1 offset:7168
  ds_read_b128 v[108:111], v1 offset:15360
  global_load_dwordx4 v[84:87], v1, s[24:25] offset:1024
  s_waitcnt vmcnt(15) lgkmcnt(2)
  v_mfma_f32_32x32x16_bf16 v[32:47], v[88:91], v[96:99], v[32:47]
  v_mfma_f32_32x32x16_bf16 v[48:63], v[88:91], v[100:103], v[48:63]
  s_waitcnt vmcnt(11) lgkmcnt(0)
  s_barrier
  ds_read_b128 v[96:99], v1 offset:16384
  ds_read_b128 v[100:103], v1 offset:24576
  s_add_u32 m0, s38, 0
  s_nop 0
  global_load_lds_dwordx4 v1, s[26:27] offset:0
  global_load_lds_dwordx4 v1, s[26:27] offset:1024
  global_load_lds_dwordx4 v1, s[26:27] offset:2048
  global_load_lds_dwordx4 v1, s[26:27] offset:3072
  s_add_u32 s26, s26, 8192
  s_addc_u32 s27, s27, 0
  global_load_dwordx4 v[88:91], v1, s[24:25] offset:2048
  s_waitcnt vmcnt(11)
  v_mfma_f32_32x32x16_bf16 v[32:47], v[92:95], v[104:107], v[32:47]
  v_mfma_f32_32x32x16_bf16 v[48:63], v[92:95], v[108:111], v[48:63]
  ds_read_b128 v[104:107], v1 offset:17408
  ds_read_b128 v[108:111], v1 offset:25600
  global_load_dwordx4 v[92:95], v1, s[24:25] offset:3072
  s_add_u32 s24, s24, 4096
  s_addc_u32 s25, s25, 0
  s_waitcnt vmcnt(11) lgkmcnt(2)
  v_mfma_f32_32x32x16_bf16 v[32:47], v[64:67], v[96:99], v[32:47]
  v_mfma_f32_32x32x16_bf16 v[48:63], v[64:67], v[100:103], v[48:63]
  ds_read_b128 v[96:99], v1 offset:18432
  ds_read_b128 v[100:103], v1 offset:26624
  global_load_dwordx4 v[64:67], v1, s[24:25] offset:0
  s_waitcnt vmcnt(11) lgkmcnt(2)
  v_mfma_f32_32x32x16_bf16 v[32:47], v[68:71], v[104:107], v[32:47]
  v_mfma_f32_32x32x16_bf16 v[48:63], v[68:71], v[108:111], v[48:63]
  ds_read_b128 v[104:107], v1 offset:19456
  ds_read_b128 v[108:111], v1 offset:27648
  global_load_dwordx4 v[68:71], v1, s[24:25] offset:1024
  s_waitcnt vmcnt(11) lgkmcnt(2)
  v_mfma_f32_32x32x16_bf16 v[32:47], v[72:75], v[96:99], v[32:47]
  v_mfma_f32_32x32x16_bf16 v[48:63], v[72:75], v[100:103], v[48:63]
  ds_read_b128 v[96:99], v1 offset:20480
  ds_read_b128 v[100:103], v1 offset:28672
  global_load_dwordx4 v[72:75], v1, s[24:25] offset:2048
  s_waitcnt vmcnt(11) lgkmcnt(2)
  v_mfma_f32_32x32x16_bf16 v[32:47], v[76:79], v[104:107], v[32:47]
  v_mfma_f32_32x32x16_bf16 v[48:63], v[76:79], v[108:111], v[48:63]
  ds_read_b128 v[104:107], v1 offset:21504
  ds_read_b128 v[108:111], v1 offset:29696
  global_load_dwordx4 v[76:79], v1, s[24:25] offset:3072
  s_add_u32 s24, s24, 4096
  s_addc_u32 s25, s25, 0
  s_waitcnt vmcnt(11) lgkmcnt(2)
  v_mfma_f32_32x32x16_bf16 v[32:47], v[80:83], v[96:99], v[32:47]
  v_mfma_f32_32x32x16_bf16 v[48:63], v[80:83], v[100:103], v[48:63]
  ds_read_b128 v[96:99], v1 offset:22528
  ds_read_b128 v[100:103], v1 offset:30720
  global_load_dwordx4 v[80:83], v1, s[24:25] offset:0
  s_waitcnt vmcnt(11) lgkmcnt(2)
  v_mfma_f32_32x32x16_bf16 v[32:47], v[84:87], v[104:107], v[32:47]
  v_mfma_f32_32x32x16_bf16 v[48:63], v[84:87], v[108:111], v[48:63]
  ds_read_b128 v[104:107], v1 offset:23552
  ds_read_b128 v[108:111], v1 offset:31744
  global_load_dwordx4 v[84:87], v1, s[24:25] offset:1024
  s_waitcnt vmcnt(7) lgkmcnt(2)
  v_mfma_f32_32x32x16_bf16 v[32:47], v[88:91], v[96:99], v[32:47]
  v_mfma_f32_32x32x16_bf16 v[48:63], v[88:91], v[100:103], v[48:63]
  s_waitcnt lgkmcnt(0)
  s_barrier
  ds_read_b128 v[96:99], v1 offset:32768
  ds_read_b128 v[100:103], v1 offset:40960
  s_add_u32 m0, s38, 16384
  s_nop 0
  global_load_lds_dwordx4 v1, s[26:27] offset:0
  global_load_lds_dwordx4 v1, s[26:27] offset:1024
  global_load_lds_dwordx4 v1, s[26:27] offset:2048
  global_load_lds_dwordx4 v1, s[26:27] offset:3072
  s_add_u32 s26, s26, 8192
  s_addc_u32 s27, s27, 0
  global_load_dwordx4 v[88:91], v1, s[24:25] offset:2048
  s_waitcnt vmcnt(11)
  v_mfma_f32_32x32x16_bf16 v[32:47], v[92:95], v[104:107], v[32:47]
  v_mfma_f32_32x32x16_bf16 v[48:63], v[92:95], v[108:111], v[48:63]
  ds_read_b128 v[104:107], v1 offset:33792
  ds_read_b128 v[108:111], v1 offset:41984
  global_load_dwordx4 v[92:95], v1, s[24:25] offset:3072
  s_add_u32 s24, s24, 4096
  s_addc_u32 s25, s25, 0
  s_waitcnt vmcnt(11) lgkmcnt(2)
  v_mfma_f32_32x32x16_bf16 v[32:47], v[64:67], v[96:99], v[32:47]
  v_mfma_f32_32x32x16_bf16 v[48:63], v[64:67], v[100:103], v[48:63]
  ds_read_b128 v[96:99], v1 offset:34816
  ds_read_b128 v[100:103], v1 offset:43008
  global_load_dwordx4 v[64:67], v1, s[24:25] offset:0
  s_waitcnt vmcnt(11) lgkmcnt(2)
  v_mfma_f32_32x32x16_bf16 v[32:47], v[68:71], v[104:107], v[32:47]
  v_mfma_f32_32x32x16_bf16 v[48:63], v[68:71], v[108:111], v[48:63]
  ds_read_b128 v[104:107], v1 offset:35840
  ds_read_b128 v[108:111], v1 offset:44032
  global_load_dwordx4 v[68:71], v1, s[24:25] offset:1024
  s_waitcnt vmcnt(11) lgkmcnt(2)
  v_mfma_f32_32x32x16_bf16 v[32:47], v[72:75], v[96:99], v[32:47]
  v_mfma_f32_32x32x16_bf16 v[48:63], v[72:75], v[100:103], v[48:63]
  ds_read_b128 v[96:99], v1 offset:36864
  ds_read_b128 v[100:103], v1 offset:45056
  global_load_dwordx4 v[72:75], v1, s[24:25] offset:2048
  s_waitcnt vmcnt(11) lgkmcnt(2)
  v_mfma_f32_32x32x16_bf16 v[32:47], v[76:79], v[104:107], v[32:47]
  v_mfma_f32_32x32x16_bf16 v[48:63], v[76:79], v[108:111], v[48:63]
  ds_read_b128 v[104:107], v1 offset:37888
  ds_read_b128 v[108:111], v1 offset:46080
  global_load_dwordx4 v[76:79], v1, s[24:25] offset:3072
  s_add_u32 s24, s24, 4096
  s_addc_u32 s25, s25, 0
  s_waitcnt vmcnt(11) lgkmcnt(2)
  v_mfma_f32_32x32x16_bf16 v[32:47], v[80:83], v[96:99], v[32:47]
  v_mfma_f32_32x32x16_bf16 v[48:63], v[80:83], v[100:103], v[48:63]
  ds_read_b128 v[96:99], v1 offset:38912
  ds_read_b128 v[100:103], v1 offset:47104
  global_load_dwordx4 v[80:83], v1, s[24:25] offset:0
  s_waitcnt vmcnt(11) lgkmcnt(2)
  v_mfma_f32_32x32x16_bf16 v[32:47], v[84:87], v[104:107], v[32:47]
  v_mfma_f32_32x32x16_bf16 v[48:63], v[84:87], v[108:111], v[48:63]
  ds_read_b128 v[104:107], v1 offset:39936
  ds_read_b128 v[108:111], v1 offset:48128
  global_load_dwordx4 v[84:87], v1, s[24:25] offset:1024
  s_waitcnt vmcnt(7) lgkmcnt(2)
  v_mfma_f32_32x32x16_bf16 v[32:47], v[88:91], v[96:99], v[32:47]
  v_mfma_f32_32x32x16_bf16 v[48:63], v[88:91], v[100:103], v[48:63]
  s_waitcnt lgkmcnt(0)
  s_barrier
  ds_read_b128 v[96:99], v1 offset:0
  ds_read_b128 v[100:103], v1 offset:8192
  global_load_dwordx4 v[88:91], v1, s[24:25] offset:2048
  s_waitcnt vmcnt(7)
  v_mfma_f32_32x32x16_bf16 v[32:47], v[92:95], v[104:107], v[32:47]
  v_mfma_f32_32x32x16_bf16 v[48:63], v[92:95], v[108:111], v[48:63]
  ds_read_b128 v[104:107], v1 offset:1024
  ds_read_b128 v[108:111], v1 offset:9216
  global_load_dwordx4 v[92:95], v1, s[24:25] offset:3072
  s_add_u32 s24, s24, 4096
  s_addc_u32 s25, s25, 0
  s_waitcnt vmcnt(7) lgkmcnt(2)
  v_mfma_f32_32x32x16_bf16 v[32:47], v[64:67], v[96:99], v[32:47]
  v_mfma_f32_32x32x16_bf16 v[48:63], v[64:67], v[100:103], v[48:63]
  ds_read_b128 v[96:99], v1 offset:2048
  ds_read_b128 v[100:103], v1 offset:10240
  global_load_dwordx4 v[64:67], v1, s[24:25] offset:0
  s_waitcnt vmcnt(7) lgkmcnt(2)
  v_mfma_f32_32x32x16_bf16 v[32:47], v[68:71], v[104:107], v[32:47]
  v_mfma_f32_32x32x16_bf16 v[48:63], v[68:71], v[108:111], v[48:63]
  ds_read_b128 v[104:107], v1 offset:3072
  ds_read_b128 v[108:111], v1 offset:11264
  global_load_dwordx4 v[68:71], v1, s[24:25] offset:1024
  s_waitcnt vmcnt(7) lgkmcnt(2)
  v_mfma_f32_32x32x16_bf16 v[32:47], v[72:75], v[96:99], v[32:47]
  v_mfma_f32_32x32x16_bf16 v[48:63], v[72:75], v[100:103], v[48:63]
  ds_read_b128 v[96:99], v1 offset:4096
  ds_read_b128 v[100:103], v1 offset:12288
  global_load_dwordx4 v[72:75], v1, s[24:25] offset:2048
  s_waitcnt vmcnt(7) lgkmcnt(2)
  v_mfma_f32_32x32x16_bf16 v[32:47], v[76:79], v[104:107], v[32:47]
  v_mfma_f32_32x32x16_bf16 v[48:63], v[76:79], v[108:111], v[48:63]
  ds_read_b128 v[104:107], v1 offset:5120
  ds_read_b128 v[108:111], v1 offset:13312
  global_load_dwordx4 v[76:79], v1, s[24:25] offset:3072
  s_add_u32 s24, s24, 4096
  s_addc_u32 s25, s25, 0
  s_waitcnt vmcnt(7) lgkmcnt(2)
  v_mfma_f32_32x32x16_bf16 v[32:47], v[80:83], v[96:99], v[32:47]
  v_mfma_f32_32x32x16_bf16 v[48:63], v[80:83], v[100:103], v[48:63]
  ds_read_b128 v[96:99], v1 offset:6144
  ds_read_b128 v[100:103], v1 offset:14336
  global_load_dwordx4 v[80:83], v1, s[24:25] offset:0
  s_waitcnt vmcnt(7) lgkmcnt(2)
  v_mfma_f32_32x32x16_bf16 v[32:47], v[84:87], v[104:107], v[32:47]
  v_mfma_f32_32x32x16_bf16 v[48:63], v[84:87], v[108:111], v[48:63]
  ds_read_b128 v[104:107], v1 offset:7168
  ds_read_b128 v[108:111], v1 offset:15360
  global_load_dwordx4 v[84:87], v1, s[24:25] offset:1024
  s_waitcnt vmcnt(7) lgkmcnt(2)
  v_mfma_f32_32x32x16_bf16 v[32:47], v[88:91], v[96:99], v[32:47]
  v_mfma_f32_32x32x16_bf16 v[48:63], v[88:91], v[100:103], v[48:63]
  s_waitcnt lgkmcnt(0)
  s_barrier
  ds_read_b128 v[96:99], v1 offset:16384
  ds_read_b128 v[100:103], v1 offset:24576
  global_load_dwordx4 v[88:91], v1, s[24:25] offset:2048
  s_waitcnt vmcnt(7)
  v_mfma_f32_32x32x16_bf16 v[32:47], v[92:95], v[104:107], v[32:47]
  v_mfma_f32_32x32x16_bf16 v[48:63], v[92:95], v[108:111], v[48:63]
  ds_read_b128 v[104:107], v1 offset:17408
  ds_read_b128 v[108:111], v1 offset:25600
  global_load_dwordx4 v[92:95], v1, s[24:25] offset:3072
  s_add_u32 s24, s24, 4096
  s_addc_u32 s25, s25, 0
  s_waitcnt vmcnt(7) lgkmcnt(2)
  v_mfma_f32_32x32x16_bf16 v[32:47], v[64:67], v[96:99], v[32:47]
  v_mfma_f32_32x32x16_bf16 v[48:63], v[64:67], v[100:103], v[48:63]
  ds_read_b128 v[96:99], v1 offset:18432
  ds_read_b128 v[100:103], v1 offset:26624
  global_load_dwordx4 v[112:115], v1, s[32:33]
  global_load_dwordx2 v[124:125], v1, s[32:33] offset:3072
  global_load_dwordx4 v[116:119], v1, s[32:33] offset:1024
  global_load_dwordx4 v[120:123], v1, s[32:33] offset:2048
  global_load_dwordx4 v[128:131], v2, s[32:33]
  global_load_dwordx2 v[140:141], v2, s[32:33] offset:3072
  global_load_dwordx4 v[132:135], v2, s[32:33] offset:1024
  global_load_dwordx4 v[136:139], v2, s[32:33] offset:2048
  global_load_dwordx4 v[144:147], v3, s[32:33]
  global_load_dwordx2 v[156:157], v3, s[32:33] offset:3072
  global_load_dwordx4 v[148:151], v3, s[32:33] offset:1024
  global_load_dwordx4 v[152:155], v3, s[32:33] offset:2048
  s_waitcnt vmcnt(18) lgkmcnt(2)
  v_mfma_f32_32x32x16_bf16 v[32:47], v[68:71], v[104:107], v[32:47]
  v_mfma_f32_32x32x16_bf16 v[48:63], v[68:71], v[108:111], v[48:63]
  ds_read_b128 v[104:107], v1 offset:19456
  ds_read_b128 v[108:111], v1 offset:27648
  s_waitcnt vmcnt(17) lgkmcnt(2)
  v_mfma_f32_32x32x16_bf16 v[32:47], v[72:75], v[96:99], v[32:47]
  v_mfma_f32_32x32x16_bf16 v[48:63], v[72:75], v[100:103], v[48:63]
  ds_read_b128 v[96:99], v1 offset:20480
  ds_read_b128 v[100:103], v1 offset:28672
  s_waitcnt vmcnt(16) lgkmcnt(2)
  v_mfma_f32_32x32x16_bf16 v[32:47], v[76:79], v[104:107], v[32:47]
  v_mfma_f32_32x32x16_bf16 v[48:63], v[76:79], v[108:111], v[48:63]
  ds_read_b128 v[104:107], v1 offset:21504
  ds_read_b128 v[108:111], v1 offset:29696
  s_waitcnt vmcnt(15) lgkmcnt(2)
  v_mfma_f32_32x32x16_bf16 v[32:47], v[80:83], v[96:99], v[32:47]
  v_mfma_f32_32x32x16_bf16 v[48:63], v[80:83], v[100:103], v[48:63]
  ds_read_b128 v[96:99], v1 offset:22528
  ds_read_b128 v[100:103], v1 offset:30720
  s_waitcnt vmcnt(14) lgkmcnt(2)
  v_mfma_f32_32x32x16_bf16 v[32:47], v[84:87], v[104:107], v[32:47]
  v_mfma_f32_32x32x16_bf16 v[48:63], v[84:87], v[108:111], v[48:63]
  ds_read_b128 v[104:107], v1 offset:23552
  ds_read_b128 v[108:111], v1 offset:31744
  s_waitcnt vmcnt(13) lgkmcnt(2)
  v_mfma_f32_32x32x16_bf16 v[32:47], v[88:91], v[96:99], v[32:47]
  v_mfma_f32_32x32x16_bf16 v[48:63], v[88:91], v[100:103], v[48:63]
  s_waitcnt vmcnt(12) lgkmcnt(0)
  v_mfma_f32_32x32x16_bf16 v[32:47], v[92:95], v[104:107], v[32:47]
  v_mfma_f32_32x32x16_bf16 v[48:63], v[92:95], v[108:111], v[48:63]
  s_mov_b32 s36, 0x53800000
  v_mov_b32 v104, 0
  v_mov_b32 v105, 0
  v_mov_b32 v106, 0
  v_mov_b32 v107, 0
  v_mov_b32 v108, 0
  v_mov_b32 v109, 0
  v_mov_b32 v110, 0
  v_mov_b32 v111, 0
  v_mov_b32 v164, 0
  v_mov_b32 v165, 0
  v_mov_b32 v166, 0
  v_mov_b32 v167, 0
  v_mov_b32 v168, 0
  v_mov_b32 v169, 0
  v_mov_b32 v170, 0
  v_mov_b32 v171, 0
  v_cvt_pk_bf16_f32 v8, v32, v33
  v_cvt_pk_bf16_f32 v9, v34, v35
  v_cvt_pk_bf16_f32 v10, v36, v37
  v_cvt_pk_bf16_f32 v11, v38, v39
  v_cvt_pk_bf16_f32 v12, v40, v41
  v_cvt_pk_bf16_f32 v13, v42, v43
  v_cvt_pk_bf16_f32 v16, v48, v49
  v_cvt_pk_bf16_f32 v17, v50, v51
  v_cvt_pk_bf16_f32 v18, v52, v53
  v_cvt_pk_bf16_f32 v19, v54, v55
  v_cvt_pk_bf16_f32 v20, v56, v57
  v_cvt_pk_bf16_f32 v21, v58, v59
  s_waitcnt vmcnt(10)
  v_mfma_f32_32x32x16_bf16 v[64:79], v[112:115], v[8:11], 0
  v_mfma_f32_32x32x8_bf16 v[64:79], v[124:125], v[12:13], v[64:79]
  v_mfma_f32_32x32x16_bf16 v[80:95], v[112:115], v[16:19], 0
  v_mfma_f32_32x32x8_bf16 v[80:95], v[124:125], v[20:21], v[80:95]
  v_mov_b32 v32, 0
  v_mov_b32 v33, 0
  v_mov_b32 v34, 0
  v_mov_b32 v35, 0
  v_mov_b32 v36, 0
  v_mov_b32 v37, 0
  v_mov_b32 v38, 0
  v_mov_b32 v39, 0
  v_mov_b32 v40, 0
  v_mov_b32 v41, 0
  v_mov_b32 v42, 0
  v_mov_b32 v43, 0
  v_mov_b32 v44, 0
  v_mov_b32 v45, 0
  v_mov_b32 v46, 0
  v_mov_b32 v47, 0
  v_mov_b32 v48, 0
  v_mov_b32 v49, 0
  v_mov_b32 v50, 0
  v_mov_b32 v51, 0
  v_mov_b32 v52, 0
  v_mov_b32 v53, 0
  v_mov_b32 v54, 0
  v_mov_b32 v55, 0
  v_mov_b32 v56, 0
  v_mov_b32 v57, 0
  v_mov_b32 v58, 0
  v_mov_b32 v59, 0
  v_mov_b32 v60, 0
  v_mov_b32 v61, 0
  v_mov_b32 v62, 0
  v_mov_b32 v63, 0
  v_max3_f32 v14, v64, v65, v66
  v_max3_f32 v192, v67, v68, v69
  v_max3_f32 v14, v14, v70, v71
  v_max3_f32 v192, v192, v72, v73
  v_max3_f32 v14, v14, v74, v75
  v_max3_f32 v192, v192, v76, v77
  v_max3_f32 v14, v14, v78, v79
  v_max_f32 v14, v14, v192
  v_mov_b32 v192, v14
  s_nop 1
  v_permlane32_swap_b32 v14, v192
  v_max_f32 v14, v14, v192
  v_add_f32 v14, 0x42c80000, v14
  v_sub_f32 v192, 0, v14
  v_and_b32 v193, 0xffff0000, v192
  v_sub_f32 v192, v192, v193
  v_and_b32 v194, 0xffff0000, v192
  v_sub_f32 v192, v192, v194
  v_lshrrev_b32 v193, 16, v193
  v_or_b32 v193, v193, v194
  v_lshrrev_b32 v192, 16, v192
  s_mov_b32 exec_lo, 0
  v_mov_b32 v12, v193
  v_mov_b32 v13, v192
  s_mov_b32 exec_lo, -1
  s_nop 1
  v_max3_f32 v22, v80, v81, v82
  v_max3_f32 v192, v83, v84, v85
  v_max3_f32 v22, v22, v86, v87
  v_max3_f32 v192, v192, v88, v89
  v_max3_f32 v22, v22, v90, v91
  v_max3_f32 v192, v192, v92, v93
  v_max3_f32 v22, v22, v94, v95
  v_max_f32 v22, v22, v192
  v_mov_b32 v192, v22
  s_nop 1
  v_permlane32_swap_b32 v22, v192
  v_max_f32 v22, v22, v192
  v_add_f32 v22, 0x42c80000, v22
  v_sub_f32 v192, 0, v22
  v_and_b32 v193, 0xffff0000, v192
  v_sub_f32 v192, v192, v193
  v_and_b32 v194, 0xffff0000, v192
  v_sub_f32 v192, v192, v194
  v_lshrrev_b32 v193, 16, v193
  v_or_b32 v193, v193, v194
  v_lshrrev_b32 v192, 16, v192
  s_mov_b32 exec_lo, 0
  v_mov_b32 v20, v193
  v_mov_b32 v21, v192
  s_mov_b32 exec_lo, -1
  s_nop 1
  v_mfma_f32_32x32x16_bf16 v[64:79], v[112:115], v[8:11], 0
  v_mfma_f32_32x32x8_bf16 v[64:79], v[124:125], v[12:13], v[64:79]
  s_mov_b32 s37, 0
  s_nop 7
  s_nop 3
L_att_loop:
  v_exp_f32 v64, v64
  v_exp_f32 v65, v65
  v_mfma_f32_32x32x16_bf16 v[80:95], v[112:115], v[16:19], 0
  global_load_dwordx4 v[160:163], v24, s[32:33]
  global_load_dwordx2 v[172:173], v24, s[32:33] offset:3072
  v_exp_f32 v66, v66
  v_exp_f32 v67, v67
  v_cvt_pk_bf16_f32 v96, v64, v65
  v_exp_f32 v68, v68
  v_exp_f32 v69, v69
  v_cvt_pk_bf16_f32 v97, v66, v67
  v_mfma_f32_32x32x8_bf16 v[80:95], v[124:125], v[20:21], v[80:95]
  v_exp_f32 v70, v70
  v_exp_f32 v71, v71
  v_cvt_pk_bf16_f32 v98, v68, v69
  v_exp_f32 v72, v72
  v_exp_f32 v73, v73
  v_cvt_pk_bf16_f32 v99, v70, v71
  v_mfma_f32_32x32x16_bf16 v[48:63], v[164:167], v[104:107], v[48:63]
  v_exp_f32 v74, v74
  v_exp_f32 v75, v75
  v_cvt_pk_bf16_f32 v100, v72, v73
  v_exp_f32 v76, v76
  v_exp_f32 v77, v77
  v_cvt_pk_bf16_f32 v101, v74, v75
  v_mfma_f32_32x32x16_bf16 v[48:63], v[168:171], v[108:111], v[48:63]
  s_waitcnt vmcnt(8)
  v_exp_f32 v78, v78
  v_exp_f32 v79, v79
  v_cvt_pk_bf16_f32 v102, v76, v77
  v_cvt_pk_bf16_f32 v103, v78, v79
  v_exp_f32 v80, v80
  v_exp_f32 v81, v81
  v_mfma_f32_32x32x16_bf16 v[64:79], v[128:131], v[8:11], 0
  global_load_dwordx4 v[164:167], v24, s[32:33] offset:1024
  global_load_dwordx4 v[168:171], v24, s[32:33] offset:2048
  v_exp_f32 v82, v82
  v_exp_f32 v83, v83
  v_cvt_pk_bf16_f32 v104, v80, v81
  v_exp_f32 v84, v84
  v_exp_f32 v85, v85
  v_cvt_pk_bf16_f32 v105, v82, v83
  v_mfma_f32_32x32x8_bf16 v[64:79], v[140:141], v[12:13], v[64:79]
  v_exp_f32 v86, v86
  v_exp_f32 v87, v87
  v_cvt_pk_bf16_f32 v106, v84, v85
  v_exp_f32 v88, v88
  v_exp_f32 v89, v89
  v_cvt_pk_bf16_f32 v107, v86, v87
  v_mfma_f32_32x32x16_bf16 v[32:47], v[116:119], v[96:99], v[32:47]
  v_exp_f32 v90, v90
  v_exp_f32 v91, v91
  v_cvt_pk_bf16_f32 v108, v88, v89
  v_exp_f32 v92, v92
  v_exp_f32 v93, v93
  v_cvt_pk_bf16_f32 v109, v90, v91
  v_mfma_f32_32x32x16_bf16 v[32:47], v[120:123], v[100:103], v[32:47]
  v_exp_f32 v94, v94
  v_exp_f32 v95, v95
  v_cvt_pk_bf16_f32 v110, v92, v93
  v_cvt_pk_bf16_f32 v111, v94, v95
  v_exp_f32 v64, v64
  v_exp_f32 v65, v65
  v_mfma_f32_32x32x16_bf16 v[80:95], v[128:131], v[16:19], 0
  global_load_dwordx4 v[112:115], v25, s[32:33]
  global_load_dwordx2 v[124:125], v25, s[32:33] offset:3072
  v_exp_f32 v66, v66
  v_exp_f32 v67, v67
  v_cvt_pk_bf16_f32 v96, v64, v65
  v_exp_f32 v68, v68
  v_exp_f32 v69, v69
  v_cvt_pk_bf16_f32 v97, v66, v67
  v_mfma_f32_32x32x8_bf16 v[80:95], v[140:141], v[20:21], v[80:95]
  v_exp_f32 v70, v70
  v_exp_f32 v71, v71
  v_cvt_pk_bf16_f32 v98, v68, v69
  v_exp_f32 v72, v72
  v_exp_f32 v73, v73
  v_cvt_pk_bf16_f32 v99, v70, v71
  v_mfma_f32_32x32x16_bf16 v[48:63], v[116:119], v[104:107], v[48:63]
  v_exp_f32 v74, v74
  v_exp_f32 v75, v75
  v_cvt_pk_bf16_f32 v100, v72, v73
  v_exp_f32 v76, v76
  v_exp_f32 v77, v77
  v_cvt_pk_bf16_f32 v101, v74, v75
  v_mfma_f32_32x32x16_bf16 v[48:63], v[120:123], v[108:111], v[48:63]
  s_waitcnt vmcnt(8)
  v_exp_f32 v78, v78
  v_exp_f32 v79, v79
  v_cvt_pk_bf16_f32 v102, v76, v77
  v_cvt_pk_bf16_f32 v103, v78, v79
  v_exp_f32 v80, v80
  v_exp_f32 v81, v81
  v_mfma_f32_32x32x16_bf16 v[64:79], v[144:147], v[8:11], 0
  global_load_dwordx4 v[116:119], v25, s[32:33] offset:1024
  global_load_dwordx4 v[120:123], v25, s[32:33] offset:2048
  v_exp_f32 v82, v82
  v_exp_f32 v83, v83
  v_cvt_pk_bf16_f32 v104, v80, v81
  v_exp_f32 v84, v84
  v_exp_f32 v85, v85
  v_cvt_pk_bf16_f32 v105, v82, v83
  v_mfma_f32_32x32x8_bf16 v[64:79], v[156:157], v[12:13], v[64:79]
  v_exp_f32 v86, v86
  v_exp_f32 v87, v87
  v_cvt_pk_bf16_f32 v106, v84, v85
  v_exp_f32 v88, v88
  v_exp_f32 v89, v89
  v_cvt_pk_bf16_f32 v107, v86, v87
  v_mfma_f32_32x32x16_bf16 v[32:47], v[132:135], v[96:99], v[32:47]
  v_exp_f32 v90, v90
  v_exp_f32 v91, v91
  v_cvt_pk_bf16_f32 v108, v88, v89
  v_exp_f32 v92, v92
  v_exp_f32 v93, v93
  v_cvt_pk_bf16_f32 v109, v90, v91
  v_mfma_f32_32x32x16_bf16 v[32:47], v[136:139], v[100:103], v[32:47]
  v_exp_f32 v94, v94
  v_exp_f32 v95, v95
  v_cvt_pk_bf16_f32 v110, v92, v93
  v_cvt_pk_bf16_f32 v111, v94, v95
  v_exp_f32 v64, v64
  v_exp_f32 v65, v65
  v_mfma_f32_32x32x16_bf16 v[80:95], v[144:147], v[16:19], 0
  global_load_dwordx4 v[128:131], v26, s[32:33]
  global_load_dwordx2 v[140:141], v26, s[32:33] offset:3072
  v_exp_f32 v66, v66
  v_exp_f32 v67, v67
  v_cvt_pk_bf16_f32 v96, v64, v65
  v_exp_f32 v68, v68
  v_exp_f32 v69, v69
  v_cvt_pk_bf16_f32 v97, v66, v67
  v_mfma_f32_32x32x8_bf16 v[80:95], v[156:157], v[20:21], v[80:95]
  v_exp_f32 v70, v70
  v_exp_f32 v71, v71
  v_cvt_pk_bf16_f32 v98, v68, v69
  v_exp_f32 v72, v72
  v_exp_f32 v73, v73
  v_cvt_pk_bf16_f32 v99, v70, v71
  v_mfma_f32_32x32x16_bf16 v[48:63], v[132:135], v[104:107], v[48:63]
  v_exp_f32 v74, v74
  v_exp_f32 v75, v75
  v_cvt_pk_bf16_f32 v100, v72, v73
  v_exp_f32 v76, v76
  v_exp_f32 v77, v77
  v_cvt_pk_bf16_f32 v101, v74, v75
  v_mfma_f32_32x32x16_bf16 v[48:63], v[136:139], v[108:111], v[48:63]
  s_waitcnt vmcnt(8)
  v_exp_f32 v78, v78
  v_exp_f32 v79, v79
  v_cvt_pk_bf16_f32 v102, v76, v77
  v_cvt_pk_bf16_f32 v103, v78, v79
  v_exp_f32 v80, v80
  v_exp_f32 v81, v81
  v_mfma_f32_32x32x16_bf16 v[64:79], v[160:163], v[8:11], 0
  global_load_dwordx4 v[132:135], v26, s[32:33] offset:1024
  global_load_dwordx4 v[136:139], v26, s[32:33] offset:2048
  v_exp_f32 v82, v82
  v_exp_f32 v83, v83
  v_cvt_pk_bf16_f32 v104, v80, v81
  v_exp_f32 v84, v84
  v_exp_f32 v85, v85
  v_cvt_pk_bf16_f32 v105, v82, v83
  v_mfma_f32_32x32x8_bf16 v[64:79], v[172:173], v[12:13], v[64:79]
  v_exp_f32 v86, v86
  v_exp_f32 v87, v87
  v_cvt_pk_bf16_f32 v106, v84, v85
  v_exp_f32 v88, v88
  v_exp_f32 v89, v89
  v_cvt_pk_bf16_f32 v107, v86, v87
  v_mfma_f32_32x32x16_bf16 v[32:47], v[148:151], v[96:99], v[32:47]
  v_exp_f32 v90, v90
  v_exp_f32 v91, v91
  v_cvt_pk_bf16_f32 v108, v88, v89
  v_exp_f32 v92, v92
  v_exp_f32 v93, v93
  v_cvt_pk_bf16_f32 v109, v90, v91
  v_mfma_f32_32x32x16_bf16 v[32:47], v[152:155], v[100:103], v[32:47]
  v_exp_f32 v94, v94
  v_exp_f32 v95, v95
  v_cvt_pk_bf16_f32 v110, v92, v93
  v_cvt_pk_bf16_f32 v111, v94, v95
  v_exp_f32 v64, v64
  v_exp_f32 v65, v65
  v_mfma_f32_32x32x16_bf16 v[80:95], v[160:163], v[16:19], 0
  global_load_dwordx4 v[144:147], v27, s[32:33]
  global_load_dwordx2 v[156:157], v27, s[32:33] offset:3072
  v_exp_f32 v66, v66
  v_exp_f32 v67, v67
  v_cvt_pk_bf16_f32 v96, v64, v65
  v_exp_f32 v68, v68
  v_exp_f32 v69, v69
  v_cvt_pk_bf16_f32 v97, v66, v67
  v_mfma_f32_32x32x8_bf16 v[80:95], v[172:173], v[20:21], v[80:95]
  v_exp_f32 v70, v70
  v_exp_f32 v71, v71
  v_cvt_pk_bf16_f32 v98, v68, v69
  v_exp_f32 v72, v72
  v_exp_f32 v73, v73
  v_cvt_pk_bf16_f32 v99, v70, v71
  v_mfma_f32_32x32x16_bf16 v[48:63], v[148:151], v[104:107], v[48:63]
  v_exp_f32 v74, v74
  v_exp_f32 v75, v75
  v_cvt_pk_bf16_f32 v100, v72, v73
  v_exp_f32 v76, v76
  v_exp_f32 v77, v77
  v_cvt_pk_bf16_f32 v101, v74, v75
  v_mfma_f32_32x32x16_bf16 v[48:63], v[152:155], v[108:111], v[48:63]
  s_waitcnt vmcnt(8)
  v_exp_f32 v78, v78
  v_exp_f32 v79, v79
  v_cvt_pk_bf16_f32 v102, v76, v77
  v_cvt_pk_bf16_f32 v103, v78, v79
  v_exp_f32 v80, v80
  v_exp_f32 v81, v81
  v_mfma_f32_32x32x16_bf16 v[64:79], v[112:115], v[8:11], 0
  global_load_dwordx4 v[148:151], v27, s[32:33] offset:1024
  global_load_dwordx4 v[152:155], v27, s[32:33] offset:2048
  v_exp_f32 v82, v82
  v_exp_f32 v83, v83
  v_cvt_pk_bf16_f32 v104, v80, v81
  v_exp_f32 v84, v84
  v_exp_f32 v85, v85
  v_cvt_pk_bf16_f32 v105, v82, v83
  v_mfma_f32_32x32x8_bf16 v[64:79], v[124:125], v[12:13], v[64:79]
  s_add_u32 s32, s32, 16384
  s_addc_u32 s33, s33, 0
  v_exp_f32 v86, v86
  v_max_f32 v192, v44, v60
  v_exp_f32 v87, v87
  v_cmp_nge_f32 vcc, s36, v192
  v_cvt_pk_bf16_f32 v106, v84, v85
  v_exp_f32 v88, v88
  v_exp_f32 v89, v89
  v_cvt_pk_bf16_f32 v107, v86, v87
  v_mfma_f32_32x32x16_bf16 v[32:47], v[164:167], v[96:99], v[32:47]
  s_add_u32 s37, s37, 4
  s_cmp_lt_u32 s37, 64
  v_exp_f32 v90, v90
  v_exp_f32 v91, v91
  v_cvt_pk_bf16_f32 v108, v88, v89
  v_exp_f32 v92, v92
  v_exp_f32 v93, v93
  v_cvt_pk_bf16_f32 v109, v90, v91
  v_mfma_f32_32x32x16_bf16 v[32:47], v[168:171], v[100:103], v[32:47]
  v_exp_f32 v94, v94
  v_exp_f32 v95, v95
  v_cvt_pk_bf16_f32 v110, v92, v93
  v_cvt_pk_bf16_f32 v111, v94, v95
  s_cbranch_vccnz L_att_rare_loop
L_att_ret:
  s_cbranch_scc1 L_att_loop
  s_nop 1
  v_mfma_f32_32x32x16_bf16 v[48:63], v[164:167], v[104:107], v[48:63]
  v_mfma_f32_32x32x16_bf16 v[48:63], v[168:171], v[108:111], v[48:63]
  s_nop 15
  s_mov_b32 s18, 0x6c800000
  v_cmp_nge_f32 vcc, s18, v44
  v_cmp_nge_f32 s[20:21], s18, v60
  s_or_b64 vcc, vcc, s[20:21]
  s_cbranch_vccz L_att_fin
  v_mov_b32 v104, 0
  v_mov_b32 v105, 0
  v_mov_b32 v106, 0
  v_mov_b32 v107, 0
  v_mov_b32 v108, 0
  v_mov_b32 v109, 0
  v_mov_b32 v110, 0
  v_mov_b32 v111, 0
  s_call_b64 s[40:41], L_att_rare
L_att_fin:
  s_mul_i32 s18, s15, 303104
  s_add_u32 s18, s18, 5570560
  s_add_u32 s26, s12, s18
  s_addc_u32 s27, s13, 0
  s_add_u32 s28, s26, 151552
  s_addc_u32 s29, s27, 0
  v_rcp_f32 v192, v44
  s_nop 0
  v_fma_f32 v193, -v44, v192, 1.0
  v_fma_f32 v192, v192, v193, v192
  v_mul_f32 v32, v32, v192
  v_mul_f32 v33, v33, v192
  v_mul_f32 v34, v34, v192
  v_mul_f32 v35, v35, v192
  v_mul_f32 v36, v36, v192
  v_mul_f32 v37, v37, v192
  v_mul_f32 v38, v38, v192
  v_mul_f32 v39, v39, v192
  v_mul_f32 v40, v40, v192
  v_mul_f32 v41, v41, v192
  v_mul_f32 v42, v42, v192
  v_mul_f32 v43, v43, v192
  v_cvt_pk_bf16_f32 v96, v32, v33
  v_cvt_pk_bf16_f32 v97, v34, v35
  v_cvt_pk_bf16_f32 v98, v36, v37
  v_cvt_pk_bf16_f32 v99, v38, v39
  v_cvt_pk_bf16_f32 v100, v40, v41
  v_cvt_pk_bf16_f32 v101, v42, v43
  global_store_dwordx2 v5, v[96:97], s[26:27]
  global_store_dwordx2 v6, v[98:99], s[26:27]
  s_mov_b32 exec_hi, 0
  global_store_dwordx2 v7, v[100:101], s[26:27]
  s_mov_b32 exec_hi, -1
  v_rcp_f32 v192, v60
  s_nop 0
  v_fma_f32 v193, -v60, v192, 1.0
  v_fma_f32 v192, v192, v193, v192
  v_mul_f32 v48, v48, v192
  v_mul_f32 v49, v49, v192
  v_mul_f32 v50, v50, v192
  v_mul_f32 v51, v51, v192
  v_mul_f32 v52, v52, v192
  v_mul_f32 v53, v53, v192
  v_mul_f32 v54, v54, v192
  v_mul_f32 v55, v55, v192
  v_mul_f32 v56, v56, v192
  v_mul_f32 v57, v57, v192
  v_mul_f32 v58, v58, v192
  v_mul_f32 v59, v59, v192
  v_cvt_pk_bf16_f32 v104, v48, v49
  v_cvt_pk_bf16_f32 v105, v50, v51
  v_cvt_pk_bf16_f32 v106, v52, v53
  v_cvt_pk_bf16_f32 v107, v54, v55
  v_cvt_pk_bf16_f32 v108, v56, v57
  v_cvt_pk_bf16_f32 v109, v58, v59
  global_store_dwordx2 v5, v[104:105], s[28:29]
  global_store_dwordx2 v6, v[106:107], s[28:29]
  s_mov_b32 exec_hi, 0
  global_store_dwordx2 v7, v[108:109], s[28:29]
  s_mov_b32 exec_hi, -1
  s_lshl_b32 s47, s15, 2
  s_add_u32 s47, s47, 32
  s_endpgm
L_att_rare_loop:
  s_call_b64 s[40:41], L_att_rare
  s_cmp_lt_u32 s37, 64
  s_branch L_att_ret
L_att_rare:
  s_nop 1
  v_mfma_f32_32x32x16_bf16 v[48:63], v[164:167], v[104:107], v[48:63]
  v_mfma_f32_32x32x16_bf16 v[48:63], v[168:171], v[108:111], v[48:63]
  s_nop 15
  v_mov_b32 v104, 0
  v_mov_b32 v105, 0
  v_mov_b32 v106, 0
  v_mov_b32 v107, 0
  v_mov_b32 v108, 0
  v_mov_b32 v109, 0
  v_mov_b32 v110, 0
  v_mov_b32 v111, 0
  s_mov_b32 s19, 0x6c800000
  v_cmp_nge_f32 s[42:43], s19, v44
  v_frexp_exp_i32_f32 v192, v44
  v_add_u32 v192, 100, v192
  v_cmp_nlt_f32 vcc, 0, v44
  s_or_b64 vcc, vcc, s[42:43]
  s_nop 1
  v_cndmask_b32 v192, v192, 0, vcc
  v_sub_u32 v193, 0, v192
  v_ldexp_f32 v32, v32, v193
  v_ldexp_f32 v33, v33, v193
  v_ldexp_f32 v34, v34, v193
  v_ldexp_f32 v35, v35, v193
  v_ldexp_f32 v36, v36, v193
  v_ldexp_f32 v37, v37, v193
  v_ldexp_f32 v38, v38, v193
  v_ldexp_f32 v39, v39, v193
  v_ldexp_f32 v40, v40, v193
  v_ldexp_f32 v41, v41, v193
  v_ldexp_f32 v42, v42, v193
  v_ldexp_f32 v43, v43, v193
  v_ldexp_f32 v44, v44, v193
  v_ldexp_f32 v45, v45, v193
  v_ldexp_f32 v46, v46, v193
  v_ldexp_f32 v47, v47, v193
  v_cvt_f32_i32 v192, v192
  v_add_f32 v196, v14, v192
  s_cmp_eq_u64 s[42:43], 0
  s_cbranch_scc1 L_att_noredo_a
  s_sub_u32 s20, s37, 8
  s_max_i32 s20, s20, 0
  s_mov_b32 s21, s20
  v_mov_b32 v198, 0xff61b1e6
L_att_rd1_a:
  s_lshl_b32 s22, s21, 12
  s_add_u32 s22, s30, s22
  s_addc_u32 s23, s31, 0
  global_load_dwordx4 v[176:179], v1, s[22:23]
  global_load_dwordx2 v[188:189], v1, s[22:23] offset:3072
  s_waitcnt vmcnt(0)
  v_mfma_f32_32x32x16_bf16 v[80:95], v[176:179], v[8:11], 0
  v_mfma_f32_32x32x8_bf16 v[80:95], v[188:189], v[12:13], v[80:95]
  s_nop 15
  v_max3_f32 v192, v80, v81, v82
  v_max3_f32 v193, v83, v84, v85
  v_max3_f32 v192, v192, v86, v87
  v_max3_f32 v193, v193, v88, v89
  v_max3_f32 v192, v192, v90, v91
  v_max3_f32 v193, v193, v92, v93
  v_max3_f32 v192, v192, v94, v95
  v_max_f32 v192, v192, v193
  v_mov_b32 v193, v192
  s_nop 1
  v_permlane32_swap_b32 v192, v193
  v_max_f32 v192, v192, v193
  v_max_f32 v198, v198, v192
  s_add_u32 s21, s21, 1
  s_cmp_lt_u32 s21, s37
  s_cbranch_scc1 L_att_rd1_a
  v_ceil_f32 v192, v198
  v_add_f32 v192, 0x42c80000, v192
  v_add_f32 v192, v14, v192
  v_cndmask_b32 v196, v196, v192, s[42:43]
  v_mov_b32 v197, 0x7f61b1e6
  v_cndmask_b32 v197, v197, v192, s[42:43]
  s_mov_b64 exec, s[42:43]
  v_mov_b32 v32, 0
  v_mov_b32 v33, 0
  v_mov_b32 v34, 0
  v_mov_b32 v35, 0
  v_mov_b32 v36, 0
  v_mov_b32 v37, 0
  v_mov_b32 v38, 0
  v_mov_b32 v39, 0
  v_mov_b32 v40, 0
  v_mov_b32 v41, 0
  v_mov_b32 v42, 0
  v_mov_b32 v43, 0
  v_mov_b32 v44, 0
  v_mov_b32 v45, 0
  v_mov_b32 v46, 0
  v_mov_b32 v47, 0
  s_mov_b64 exec, -1
  v_sub_f32 v192, 0, v197
  v_and_b32 v193, 0xffff0000, v192
  v_sub_f32 v192, v192, v193
  v_and_b32 v194, 0xffff0000, v192
  v_sub_f32 v192, v192, v194
  v_lshrrev_b32 v193, 16, v193
  v_or_b32 v193, v193, v194
  v_lshrrev_b32 v192, 16, v192
  s_mov_b32 exec_lo, 0
  v_mov_b32 v12, v193
  v_mov_b32 v13, v192
  s_mov_b32 exec_lo, -1
  s_nop 1
  s_mov_b32 s21, s20
L_att_rd2_a:
  s_lshl_b32 s22, s21, 12
  s_add_u32 s22, s30, s22
  s_addc_u32 s23, s31, 0
  global_load_dwordx4 v[176:179], v1, s[22:23]
  global_load_dwordx2 v[188:189], v1, s[22:23] offset:3072
  global_load_dwordx4 v[180:183], v1, s[22:23] offset:1024
  global_load_dwordx4 v[184:187], v1, s[22:23] offset:2048
  s_waitcnt vmcnt(0)
  v_mfma_f32_32x32x16_bf16 v[80:95], v[176:179], v[8:11], 0
  v_mfma_f32_32x32x8_bf16 v[80:95], v[188:189], v[12:13], v[80:95]
  s_nop 15
  v_exp_f32 v80, v80
  v_exp_f32 v81, v81
  v_exp_f32 v82, v82
  v_exp_f32 v83, v83
  v_cvt_pk_bf16_f32 v104, v80, v81
  v_exp_f32 v84, v84
  v_exp_f32 v85, v85
  v_cvt_pk_bf16_f32 v105, v82, v83
  v_exp_f32 v86, v86
  v_exp_f32 v87, v87
  v_cvt_pk_bf16_f32 v106, v84, v85
  v_exp_f32 v88, v88
  v_exp_f32 v89, v89
  v_cvt_pk_bf16_f32 v107, v86, v87
  v_exp_f32 v90, v90
  v_exp_f32 v91, v91
  v_cvt_pk_bf16_f32 v108, v88, v89
  v_exp_f32 v92, v92
  v_exp_f32 v93, v93
  v_cvt_pk_bf16_f32 v109, v90, v91
  v_exp_f32 v94, v94
  v_exp_f32 v95, v95
  v_cvt_pk_bf16_f32 v110, v92, v93
  v_cvt_pk_bf16_f32 v111, v94, v95
  s_nop 1
  v_mfma_f32_32x32x16_bf16 v[32:47], v[180:183], v[104:107], v[32:47]
  v_mfma_f32_32x32x16_bf16 v[32:47], v[184:187], v[108:111], v[32:47]
  s_nop 15
  s_add_u32 s21, s21, 1
  s_cmp_lt_u32 s21, s37
  s_cbranch_scc1 L_att_rd2_a
  v_mov_b32 v104, 0
  v_mov_b32 v105, 0
  v_mov_b32 v106, 0
  v_mov_b32 v107, 0
  v_mov_b32 v108, 0
  v_mov_b32 v109, 0
  v_mov_b32 v110, 0
  v_mov_b32 v111, 0
L_att_noredo_a:
  v_sub_f32 v192, v196, v14
  v_sub_f32 v64, v64, v192
  v_sub_f32 v65, v65, v192
  v_sub_f32 v66, v66, v192
  v_sub_f32 v67, v67, v192
  v_sub_f32 v68, v68, v192
  v_sub_f32 v69, v69, v192
  v_sub_f32 v70, v70, v192
  v_sub_f32 v71, v71, v192
  v_sub_f32 v72, v72, v192
  v_sub_f32 v73, v73, v192
  v_sub_f32 v74, v74, v192
  v_sub_f32 v75, v75, v192
  v_sub_f32 v76, v76, v192
  v_sub_f32 v77, v77, v192
  v_sub_f32 v78, v78, v192
  v_sub_f32 v79, v79, v192
  v_mov_b32 v14, v196
  v_sub_f32 v192, 0, v14
  v_and_b32 v193, 0xffff0000, v192
  v_sub_f32 v192, v192, v193
  v_and_b32 v194, 0xffff0000, v192
  v_sub_f32 v192, v192, v194
  v_lshrrev_b32 v193, 16, v193
  v_or_b32 v193, v193, v194
  v_lshrrev_b32 v192, 16, v192
  s_mov_b32 exec_lo, 0
  v_mov_b32 v12, v193
  v_mov_b32 v13, v192
  s_mov_b32 exec_lo, -1
  s_nop 1
  s_mov_b32 s19, 0x6c800000
  v_cmp_nge_f32 s[42:43], s19, v60
  v_frexp_exp_i32_f32 v192, v60
  v_add_u32 v192, 100, v192
  v_cmp_nlt_f32 vcc, 0, v60
  s_or_b64 vcc, vcc, s[42:43]
  s_nop 1
  v_cndmask_b32 v192, v192, 0, vcc
  v_sub_u32 v193, 0, v192
  v_ldexp_f32 v48, v48, v193
  v_ldexp_f32 v49, v49, v193
  v_ldexp_f32 v50, v50, v193
  v_ldexp_f32 v51, v51, v193
  v_ldexp_f32 v52, v52, v193
  v_ldexp_f32 v53, v53, v193
  v_ldexp_f32 v54, v54, v193
  v_ldexp_f32 v55, v55, v193
  v_ldexp_f32 v56, v56, v193
  v_ldexp_f32 v57, v57, v193
  v_ldexp_f32 v58, v58, v193
  v_ldexp_f32 v59, v59, v193
  v_ldexp_f32 v60, v60, v193
  v_ldexp_f32 v61, v61, v193
  v_ldexp_f32 v62, v62, v193
  v_ldexp_f32 v63, v63, v193
  v_cvt_f32_i32 v192, v192
  v_add_f32 v196, v22, v192
  s_cmp_eq_u64 s[42:43], 0
  s_cbranch_scc1 L_att_noredo_b
  s_sub_u32 s20, s37, 8
  s_max_i32 s20, s20, 0
  s_mov_b32 s21, s20
  v_mov_b32 v198, 0xff61b1e6
L_att_rd1_b:
  s_lshl_b32 s22, s21, 12
  s_add_u32 s22, s30, s22
  s_addc_u32 s23, s31, 0
  global_load_dwordx4 v[176:179], v1, s[22:23]
  global_load_dwordx2 v[188:189], v1, s[22:23] offset:3072
  s_waitcnt vmcnt(0)
  v_mfma_f32_32x32x16_bf16 v[80:95], v[176:179], v[16:19], 0
  v_mfma_f32_32x32x8_bf16 v[80:95], v[188:189], v[20:21], v[80:95]
  s_nop 15
  v_max3_f32 v192, v80, v81, v82
  v_max3_f32 v193, v83, v84, v85
  v_max3_f32 v192, v192, v86, v87
  v_max3_f32 v193, v193, v88, v89
  v_max3_f32 v192, v192, v90, v91
  v_max3_f32 v193, v193, v92, v93
  v_max3_f32 v192, v192, v94, v95
  v_max_f32 v192, v192, v193
  v_mov_b32 v193, v192
  s_nop 1
  v_permlane32_swap_b32 v192, v193
  v_max_f32 v192, v192, v193
  v_max_f32 v198, v198, v192
  s_add_u32 s21, s21, 1
  s_cmp_lt_u32 s21, s37
  s_cbranch_scc1 L_att_rd1_b
  v_ceil_f32 v192, v198
  v_add_f32 v192, 0x42c80000, v192
  v_add_f32 v192, v22, v192
  v_cndmask_b32 v196, v196, v192, s[42:43]
  v_mov_b32 v197, 0x7f61b1e6
  v_cndmask_b32 v197, v197, v192, s[42:43]
  s_mov_b64 exec, s[42:43]
  v_mov_b32 v48, 0
  v_mov_b32 v49, 0
  v_mov_b32 v50, 0
  v_mov_b32 v51, 0
  v_mov_b32 v52, 0
  v_mov_b32 v53, 0
  v_mov_b32 v54, 0
  v_mov_b32 v55, 0
  v_mov_b32 v56, 0
  v_mov_b32 v57, 0
  v_mov_b32 v58, 0
  v_mov_b32 v59, 0
  v_mov_b32 v60, 0
  v_mov_b32 v61, 0
  v_mov_b32 v62, 0
  v_mov_b32 v63, 0
  s_mov_b64 exec, -1
  v_sub_f32 v192, 0, v197
  v_and_b32 v193, 0xffff0000, v192
  v_sub_f32 v192, v192, v193
  v_and_b32 v194, 0xffff0000, v192
  v_sub_f32 v192, v192, v194
  v_lshrrev_b32 v193, 16, v193
  v_or_b32 v193, v193, v194
  v_lshrrev_b32 v192, 16, v192
  s_mov_b32 exec_lo, 0
  v_mov_b32 v20, v193
  v_mov_b32 v21, v192
  s_mov_b32 exec_lo, -1
  s_nop 1
  s_mov_b32 s21, s20
L_att_rd2_b:
  s_lshl_b32 s22, s21, 12
  s_add_u32 s22, s30, s22
  s_addc_u32 s23, s31, 0
  global_load_dwordx4 v[176:179], v1, s[22:23]
  global_load_dwordx2 v[188:189], v1, s[22:23] offset:3072
  global_load_dwordx4 v[180:183], v1, s[22:23] offset:1024
  global_load_dwordx4 v[184:187], v1, s[22:23] offset:2048
  s_waitcnt vmcnt(0)
  v_mfma_f32_32x32x16_bf16 v[80:95], v[176:179], v[16:19], 0
  v_mfma_f32_32x32x8_bf16 v[80:95], v[188:189], v[20:21], v[80:95]
  s_nop 15
  v_exp_f32 v80, v80
  v_exp_f32 v81, v81
  v_exp_f32 v82, v82
  v_exp_f32 v83, v83
  v_cvt_pk_bf16_f32 v104, v80, v81
  v_exp_f32 v84, v84
  v_exp_f32 v85, v85
  v_cvt_pk_bf16_f32 v105, v82, v83
  v_exp_f32 v86, v86
  v_exp_f32 v87, v87
  v_cvt_pk_bf16_f32 v106, v84, v85
  v_exp_f32 v88, v88
  v_exp_f32 v89, v89
  v_cvt_pk_bf16_f32 v107, v86, v87
  v_exp_f32 v90, v90
  v_exp_f32 v91, v91
  v_cvt_pk_bf16_f32 v108, v88, v89
  v_exp_f32 v92, v92
  v_exp_f32 v93, v93
  v_cvt_pk_bf16_f32 v109, v90, v91
  v_exp_f32 v94, v94
  v_exp_f32 v95, v95
  v_cvt_pk_bf16_f32 v110, v92, v93
  v_cvt_pk_bf16_f32 v111, v94, v95
  s_nop 1
  v_mfma_f32_32x32x16_bf16 v[48:63], v[180:183], v[104:107], v[48:63]
  v_mfma_f32_32x32x16_bf16 v[48:63], v[184:187], v[108:111], v[48:63]
  s_nop 15
  s_add_u32 s21, s21, 1
  s_cmp_lt_u32 s21, s37
  s_cbranch_scc1 L_att_rd2_b
  v_mov_b32 v104, 0
  v_mov_b32 v105, 0
  v_mov_b32 v106, 0
  v_mov_b32 v107, 0
  v_mov_b32 v108, 0
  v_mov_b32 v109, 0
  v_mov_b32 v110, 0
  v_mov_b32 v111, 0
L_att_noredo_b:
  v_mov_b32 v22, v196
  v_sub_f32 v192, 0, v22
  v_and_b32 v193, 0xffff0000, v192
  v_sub_f32 v192, v192, v193
  v_and_b32 v194, 0xffff0000, v192
  v_sub_f32 v192, v192, v194
  v_lshrrev_b32 v193, 16, v193
  v_or_b32 v193, v193, v194
  v_lshrrev_b32 v192, 16, v192
  s_mov_b32 exec_lo, 0
  v_mov_b32 v20, v193
  v_mov_b32 v21, v192
  s_mov_b32 exec_lo, -1
  s_nop 1
  s_setpc_b64 s[40:41]
L_role_gu:
  s_sub_u32 s2, s2, 256
  s_setprio 0
  s_load_dwordx2 s[12:13], s[0:1], 88
  s_load_dwordx2 s[44:45], s[0:1], 80
  v_and_b32 v1, 63, v0
  v_lshrrev_b32 v2, 6, v0
  s_and_b32 s14, s2, 7
  v_readfirstlane_b32 s3, v2
  s_lshr_b32 s15, s2, 3
  s_and_b32 s16, s14, 1
  s_lshl_b32 s16, s16, 2
  s_and_b32 s17, s15, 3
  s_add_u32 s16, s16, s17
  s_lshr_b32 s17, s14, 1
  s_mul_i32 s17, s17, 7
  s_lshr_b32 s18, s15, 2
  s_add_u32 s17, s17, s18
  s_cmp_ge_u32 s18, 7
  s_cbranch_scc1 L_gu_exit
  s_cmp_ge_u32 s17, 27
  s_cbranch_scc1 L_gu_exit
  v_lshlrev_b32 v1, 4, v1
  s_lshl_b32 s27, s3, 12
  s_mul_i32 s22, s17, 163840
  s_add_u32 s22, s22, s27
  s_add_u32 s22, s22, 16580608
  s_lshl_b32 s28, s16, 3
  s_lshl_b32 s29, s3, 1
  s_add_u32 s28, s28, s29
  s_mul_i32 s29, s28, 40960
  s_add_u32 s29, s29, 0
  s_waitcnt lgkmcnt(0)
  s_add_u32 s20, s12, s22
  s_addc_u32 s21, s13, 0
  s_add_u32 s30, s12, s29
  s_addc_u32 s31, s13, 0
  s_add_u32 s32, s30, 40960
  s_addc_u32 s33, s31, 0
  s_add_u32 m0, s27, 0
  s_nop 0
  global_load_lds_dwordx4 v1, s[20:21] offset:0
  global_load_lds_dwordx4 v1, s[20:21] offset:1024
  global_load_lds_dwordx4 v1, s[20:21] offset:2048
  global_load_lds_dwordx4 v1, s[20:21] offset:3072
  s_add_u32 s20, s20, 16384
  s_addc_u32 s21, s21, 0
  global_load_dwordx4 v[96:99], v1, s[30:31] offset:0
  global_load_dwordx4 v[100:103], v1, s[32:33] offset:0
  global_load_dwordx4 v[104:107], v1, s[30:31] offset:1024
  global_load_dwordx4 v[108:111], v1, s[32:33] offset:1024
  global_load_dwordx4 v[112:115], v1, s[30:31] offset:2048
  global_load_dwordx4 v[116:119], v1, s[32:33] offset:2048
  s_add_u32 m0, s27, 16384
  s_nop 0
  global_load_lds_dwordx4 v1, s[20:21] offset:0
  global_load_lds_dwordx4 v1, s[20:21] offset:1024
  global_load_lds_dwordx4 v1, s[20:21] offset:2048
  global_load_lds_dwordx4 v1, s[20:21] offset:3072
  s_add_u32 s20, s20, 16384
  s_addc_u32 s21, s21, 0
  s_add_u32 m0, s27, 32768
  s_nop 0
  global_load_lds_dwordx4 v1, s[20:21] offset:0
  global_load_lds_dwordx4 v1, s[20:21] offset:1024
  global_load_lds_dwordx4 v1, s[20:21] offset:2048
  global_load_lds_dwordx4 v1, s[20:21] offset:3072
  s_add_u32 s20, s20, 16384
  s_addc_u32 s21, s21, 0
  s_waitcnt vmcnt(14)
  s_barrier
  ds_read_b128 v[64:67], v1 offset:0
  ds_read_b128 v[68:71], v1 offset:1024
  ds_read_b128 v[72:75], v1 offset:2048
  ds_read_b128 v[76:79], v1 offset:3072
  ds_read_b128 v[80:83], v1 offset:4096
  ds_read_b128 v[84:87], v1 offset:5120
  ds_read_b128 v[88:91], v1 offset:6144
  ds_read_b128 v[92:95], v1 offset:7168
  global_load_dwordx4 v[120:123], v1, s[30:31] offset:3072
  global_load_dwordx4 v[124:127], v1, s[32:33] offset:3072
  s_add_u32 s30, s30, 4096
  s_addc_u32 s31, s31, 0
  s_add_u32 s32, s32, 4096
  s_addc_u32 s33, s33, 0
  s_waitcnt vmcnt(14) lgkmcnt(4)
  v_mfma_f32_32x32x16_bf16 v[128:143], v[64:67], v[96:99], 0
  v_mfma_f32_32x32x16_bf16 v[192:207], v[64:67], v[100:103], 0
  v_mfma_f32_32x32x16_bf16 v[144:159], v[68:71], v[96:99], 0
  v_mfma_f32_32x32x16_bf16 v[208:223], v[68:71], v[100:103], 0
  v_mfma_f32_32x32x16_bf16 v[160:175], v[72:75], v[96:99], 0
  v_mfma_f32_32x32x16_bf16 v[224:239], v[72:75], v[100:103], 0
  v_mfma_f32_32x32x16_bf16 v[176:191], v[76:79], v[96:99], 0
  v_mfma_f32_32x32x16_bf16 v[240:255], v[76:79], v[100:103], 0
  ds_read_b128 v[64:67], v1 offset:8192
  ds_read_b128 v[68:71], v1 offset:9216
  ds_read_b128 v[72:75], v1 offset:10240
  ds_read_b128 v[76:79], v1 offset:11264
  global_load_dwordx4 v[96:99], v1, s[30:31] offset:0
  global_load_dwordx4 v[100:103], v1, s[32:33] offset:0
  s_waitcnt vmcnt(14) lgkmcnt(4)
  v_mfma_f32_32x32x16_bf16 v[128:143], v[80:83], v[104:107], v[128:143]
  v_mfma_f32_32x32x16_bf16 v[192:207], v[80:83], v[108:111], v[192:207]
  v_mfma_f32_32x32x16_bf16 v[144:159], v[84:87], v[104:107], v[144:159]
  v_mfma_f32_32x32x16_bf16 v[208:223], v[84:87], v[108:111], v[208:223]
  v_mfma_f32_32x32x16_bf16 v[160:175], v[88:91], v[104:107], v[160:175]
  v_mfma_f32_32x32x16_bf16 v[224:239], v[88:91], v[108:111], v[224:239]
  v_mfma_f32_32x32x16_bf16 v[176:191], v[92:95], v[104:107], v[176:191]
  v_mfma_f32_32x32x16_bf16 v[240:255], v[92:95], v[108:111], v[240:255]
  ds_read_b128 v[80:83], v1 offset:12288
  ds_read_b128 v[84:87], v1 offset:13312
  ds_read_b128 v[88:91], v1 offset:14336
  ds_read_b128 v[92:95], v1 offset:15360
  global_load_dwordx4 v[104:107], v1, s[30:31] offset:1024
  global_load_dwordx4 v[108:111], v1, s[32:33] offset:1024
  s_waitcnt vmcnt(14) lgkmcnt(4)
  v_mfma_f32_32x32x16_bf16 v[128:143], v[64:67], v[112:115], v[128:143]
  v_mfma_f32_32x32x16_bf16 v[192:207], v[64:67], v[116:119], v[192:207]
  v_mfma_f32_32x32x16_bf16 v[144:159], v[68:71], v[112:115], v[144:159]
  v_mfma_f32_32x32x16_bf16 v[208:223], v[68:71], v[116:119], v[208:223]
  v_mfma_f32_32x32x16_bf16 v[160:175], v[72:75], v[112:115], v[160:175]
  v_mfma_f32_32x32x16_bf16 v[224:239], v[72:75], v[116:119], v[224:239]
  v_mfma_f32_32x32x16_bf16 v[176:191], v[76:79], v[112:115], v[176:191]
  v_mfma_f32_32x32x16_bf16 v[240:255], v[76:79], v[116:119], v[240:255]
  s_waitcnt vmcnt(10) lgkmcnt(0)
  s_barrier
  ds_read_b128 v[64:67], v1 offset:16384
  ds_read_b128 v[68:71], v1 offset:17408
  ds_read_b128 v[72:75], v1 offset:18432
  ds_read_b128 v[76:79], v1 offset:19456
  s_add_u32 m0, s27, 0
  s_nop 0
  global_load_lds_dwordx4 v1, s[20:21] offset:0
  global_load_lds_dwordx4 v1, s[20:21] offset:1024
  global_load_lds_dwordx4 v1, s[20:21] offset:2048
  global_load_lds_dwordx4 v1, s[20:21] offset:3072
  s_add_u32 s20, s20, 16384
  s_addc_u32 s21, s21, 0
  global_load_dwordx4 v[112:115], v1, s[30:31] offset:2048
  global_load_dwordx4 v[116:119], v1, s[32:33] offset:2048
  s_waitcnt vmcnt(10)
  v_mfma_f32_32x32x16_bf16 v[128:143], v[80:83], v[120:123], v[128:143]
  v_mfma_f32_32x32x16_bf16 v[192:207], v[80:83], v[124:127], v[192:207]
  v_mfma_f32_32x32x16_bf16 v[144:159], v[84:87], v[120:123], v[144:159]
  v_mfma_f32_32x32x16_bf16 v[208:223], v[84:87], v[124:127], v[208:223]
  v_mfma_f32_32x32x16_bf16 v[160:175], v[88:91], v[120:123], v[160:175]
  v_mfma_f32_32x32x16_bf16 v[224:239], v[88:91], v[124:127], v[224:239]
  v_mfma_f32_32x32x16_bf16 v[176:191], v[92:95], v[120:123], v[176:191]
  v_mfma_f32_32x32x16_bf16 v[240:255], v[92:95], v[124:127], v[240:255]
  ds_read_b128 v[80:83], v1 offset:20480
  ds_read_b128 v[84:87], v1 offset:21504
  ds_read_b128 v[88:91], v1 offset:22528
  ds_read_b128 v[92:95], v1 offset:23552
  global_load_dwordx4 v[120:123], v1, s[30:31] offset:3072
  global_load_dwordx4 v[124:127], v1, s[32:33] offset:3072
  s_add_u32 s30, s30, 4096
  s_addc_u32 s31, s31, 0
  s_add_u32 s32, s32, 4096
  s_addc_u32 s33, s33, 0
  s_waitcnt vmcnt(10) lgkmcnt(4)
  v_mfma_f32_32x32x16_bf16 v[128:143], v[64:67], v[96:99], v[128:143]
  v_mfma_f32_32x32x16_bf16 v[192:207], v[64:67], v[100:103], v[192:207]
  v_mfma_f32_32x32x16_bf16 v[144:159], v[68:71], v[96:99], v[144:159]
  v_mfma_f32_32x32x16_bf16 v[208:223], v[68:71], v[100:103], v[208:223]
  v_mfma_f32_32x32x16_bf16 v[160:175], v[72:75], v[96:99], v[160:175]
  v_mfma_f32_32x32x16_bf16 v[224:239], v[72:75], v[100:103], v[224:239]
  v_mfma_f32_32x32x16_bf16 v[176:191], v[76:79], v[96:99], v[176:191]
  v_mfma_f32_32x32x16_bf16 v[240:255], v[76:79], v[100:103], v[240:255]
  ds_read_b128 v[64:67], v1 offset:24576
  ds_read_b128 v[68:71], v1 offset:25600
  ds_read_b128 v[72:75], v1 offset:26624
  ds_read_b128 v[76:79], v1 offset:27648
  global_load_dwordx4 v[96:99], v1, s[30:31] offset:0
  global_load_dwordx4 v[100:103], v1, s[32:33] offset:0
  s_waitcnt vmcnt(10) lgkmcnt(4)
  v_mfma_f32_32x32x16_bf16 v[128:143], v[80:83], v[104:107], v[128:143]
  v_mfma_f32_32x32x16_bf16 v[192:207], v[80:83], v[108:111], v[192:207]
  v_mfma_f32_32x32x16_bf16 v[144:159], v[84:87], v[104:107], v[144:159]
  v_mfma_f32_32x32x16_bf16 v[208:223], v[84:87], v[108:111], v[208:223]
  v_mfma_f32_32x32x16_bf16 v[160:175], v[88:91], v[104:107], v[160:175]
  v_mfma_f32_32x32x16_bf16 v[224:239], v[88:91], v[108:111], v[224:239]
  v_mfma_f32_32x32x16_bf16 v[176:191], v[92:95], v[104:107], v[176:191]
  v_mfma_f32_32x32x16_bf16 v[240:255], v[92:95], v[108:111], v[240:255]
  ds_read_b128 v[80:83], v1 offset:28672
  ds_read_b128 v[84:87], v1 offset:29696
  ds_read_b128 v[88:91], v1 offset:30720
  ds_read_b128 v[92:95], v1 offset:31744
  global_load_dwordx4 v[104:107], v1, s[30:31] offset:1024
  global_load_dwordx4 v[108:111], v1, s[32:33] offset:1024
  s_waitcnt vmcnt(6) lgkmcnt(4)
  v_mfma_f32_32x32x16_bf16 v[128:143], v[64:67], v[112:115], v[128:143]
  v_mfma_f32_32x32x16_bf16 v[192:207], v[64:67], v[116:119], v[192:207]
  v_mfma_f32_32x32x16_bf16 v[144:159], v[68:71], v[112:115], v[144:159]
  v_mfma_f32_32x32x16_bf16 v[208:223], v[68:71], v[116:119], v[208:223]
  v_mfma_f32_32x32x16_bf16 v[160:175], v[72:75], v[112:115], v[160:175]
  v_mfma_f32_32x32x16_bf16 v[224:239], v[72:75], v[116:119], v[224:239]
  v_mfma_f32_32x32x16_bf16 v[176:191], v[76:79], v[112:115], v[176:191]
  v_mfma_f32_32x32x16_bf16 v[240:255], v[76:79], v[116:119], v[240:255]
  s_waitcnt lgkmcnt(0)
  s_barrier
  ds_read_b128 v[64:67], v1 offset:32768
  ds_read_b128 v[68:71], v1 offset:33792
  ds_read_b128 v[72:75], v1 offset:34816
  ds_read_b128 v[76:79], v1 offset:35840
  s_add_u32 m0, s27, 16384
  s_nop 0
  global_load_lds_dwordx4 v1, s[20:21] offset:0
  global_load_lds_dwordx4 v1, s[20:21] offset:1024
  global_load_lds_dwordx4 v1, s[20:21] offset:2048
  global_load_lds_dwordx4 v1, s[20:21] offset:3072
  s_add_u32 s20, s20, 16384
  s_addc_u32 s21, s21, 0
  global_load_dwordx4 v[112:115], v1, s[30:31] offset:2048
  global_load_dwordx4 v[116:119], v1, s[32:33] offset:2048
  s_waitcnt vmcnt(10)
  v_mfma_f32_32x32x16_bf16 v[128:143], v[80:83], v[120:123], v[128:143]
  v_mfma_f32_32x32x16_bf16 v[192:207], v[80:83], v[124:127], v[192:207]
  v_mfma_f32_32x32x16_bf16 v[144:159], v[84:87], v[120:123], v[144:159]
  v_mfma_f32_32x32x16_bf16 v[208:223], v[84:87], v[124:127], v[208:223]
  v_mfma_f32_32x32x16_bf16 v[160:175], v[88:91], v[120:123], v[160:175]
  v_mfma_f32_32x32x16_bf16 v[224:239], v[88:91], v[124:127], v[224:239]
  v_mfma_f32_32x32x16_bf16 v[176:191], v[92:95], v[120:123], v[176:191]
  v_mfma_f32_32x32x16_bf16 v[240:255], v[92:95], v[124:127], v[240:255]
  ds_read_b128 v[80:83], v1 offset:36864
  ds_read_b128 v[84:87], v1 offset:37888
  ds_read_b128 v[88:91], v1 offset:38912
  ds_read_b128 v[92:95], v1 offset:39936
  global_load_dwordx4 v[120:123], v1, s[30:31] offset:3072
  global_load_dwordx4 v[124:127], v1, s[32:33] offset:3072
  s_add_u32 s30, s30, 4096
  s_addc_u32 s31, s31, 0
  s_add_u32 s32, s32, 4096
  s_addc_u32 s33, s33, 0
  s_waitcnt vmcnt(10) lgkmcnt(4)
  v_mfma_f32_32x32x16_bf16 v[128:143], v[64:67], v[96:99], v[128:143]
  v_mfma_f32_32x32x16_bf16 v[192:207], v[64:67], v[100:103], v[192:207]
  v_mfma_f32_32x32x16_bf16 v[144:159], v[68:71], v[96:99], v[144:159]
  v_mfma_f32_32x32x16_bf16 v[208:223], v[68:71], v[100:103], v[208:223]
  v_mfma_f32_32x32x16_bf16 v[160:175], v[72:75], v[96:99], v[160:175]
  v_mfma_f32_32x32x16_bf16 v[224:239], v[72:75], v[100:103], v[224:239]
  v_mfma_f32_32x32x16_bf16 v[176:191], v[76:79], v[96:99], v[176:191]
  v_mfma_f32_32x32x16_bf16 v[240:255], v[76:79], v[100:103], v[240:255]
  ds_read_b128 v[64:67], v1 offset:40960
  ds_read_b128 v[68:71], v1 offset:41984
  ds_read_b128 v[72:75], v1 offset:43008
  ds_read_b128 v[76:79], v1 offset:44032
  global_load_dwordx4 v[96:99], v1, s[30:31] offset:0
  global_load_dwordx4 v[100:103], v1, s[32:33] offset:0
  s_waitcnt vmcnt(10) lgkmcnt(4)
  v_mfma_f32_32x32x16_bf16 v[128:143], v[80:83], v[104:107], v[128:143]
  v_mfma_f32_32x32x16_bf16 v[192:207], v[80:83], v[108:111], v[192:207]
  v_mfma_f32_32x32x16_bf16 v[144:159], v[84:87], v[104:107], v[144:159]
  v_mfma_f32_32x32x16_bf16 v[208:223], v[84:87], v[108:111], v[208:223]
  v_mfma_f32_32x32x16_bf16 v[160:175], v[88:91], v[104:107], v[160:175]
  v_mfma_f32_32x32x16_bf16 v[224:239], v[88:91], v[108:111], v[224:239]
  v_mfma_f32_32x32x16_bf16 v[176:191], v[92:95], v[104:107], v[176:191]
  v_mfma_f32_32x32x16_bf16 v[240:255], v[92:95], v[108:111], v[240:255]
  ds_read_b128 v[80:83], v1 offset:45056
  ds_read_b128 v[84:87], v1 offset:46080
  ds_read_b128 v[88:91], v1 offset:47104
  ds_read_b128 v[92:95], v1 offset:48128
  global_load_dwordx4 v[104:107], v1, s[30:31] offset:1024
  global_load_dwordx4 v[108:111], v1, s[32:33] offset:1024
  s_waitcnt vmcnt(6) lgkmcnt(4)
  v_mfma_f32_32x32x16_bf16 v[128:143], v[64:67], v[112:115], v[128:143]
  v_mfma_f32_32x32x16_bf16 v[192:207], v[64:67], v[116:119], v[192:207]
  v_mfma_f32_32x32x16_bf16 v[144:159], v[68:71], v[112:115], v[144:159]
  v_mfma_f32_32x32x16_bf16 v[208:223], v[68:71], v[116:119], v[208:223]
  v_mfma_f32_32x32x16_bf16 v[160:175], v[72:75], v[112:115], v[160:175]
  v_mfma_f32_32x32x16_bf16 v[224:239], v[72:75], v[116:119], v[224:239]
  v_mfma_f32_32x32x16_bf16 v[176:191], v[76:79], v[112:115], v[176:191]
  v_mfma_f32_32x32x16_bf16 v[240:255], v[76:79], v[116:119], v[240:255]
  s_waitcnt lgkmcnt(0)
  s_barrier
  ds_read_b128 v[64:67], v1 offset:0
  ds_read_b128 v[68:71], v1 offset:1024
  ds_read_b128 v[72:75], v1 offset:2048
  ds_read_b128 v[76:79], v1 offset:3072
  s_add_u32 m0, s27, 32768
  s_nop 0
  global_load_lds_dwordx4 v1, s[20:21] offset:0
  global_load_lds_dwordx4 v1, s[20:21] offset:1024
  global_load_lds_dwordx4 v1, s[20:21] offset:2048
  global_load_lds_dwordx4 v1, s[20:21] offset:3072
  s_add_u32 s20, s20, 16384
  s_addc_u32 s21, s21, 0
  global_load_dwordx4 v[112:115], v1, s[30:31] offset:2048
  global_load_dwordx4 v[116:119], v1, s[32:33] offset:2048
  s_waitcnt vmcnt(10)
  v_mfma_f32_32x32x16_bf16 v[128:143], v[80:83], v[120:123], v[128:143]
  v_mfma_f32_32x32x16_bf16 v[192:207], v[80:83], v[124:127], v[192:207]
  v_mfma_f32_32x32x16_bf16 v[144:159], v[84:87], v[120:123], v[144:159]
  v_mfma_f32_32x32x16_bf16 v[208:223], v[84:87], v[124:127], v[208:223]
  v_mfma_f32_32x32x16_bf16 v[160:175], v[88:91], v[120:123], v[160:175]
  v_mfma_f32_32x32x16_bf16 v[224:239], v[88:91], v[124:127], v[224:239]
  v_mfma_f32_32x32x16_bf16 v[176:191], v[92:95], v[120:123], v[176:191]
  v_mfma_f32_32x32x16_bf16 v[240:255], v[92:95], v[124:127], v[240:255]
  ds_read_b128 v[80:83], v1 offset:4096
  ds_read_b128 v[84:87], v1 offset:5120
  ds_read_b128 v[88:91], v1 offset:6144
  ds_read_b128 v[92:95], v1 offset:7168
  global_load_dwordx4 v[120:123], v1, s[30:31] offset:3072
  global_load_dwordx4 v[124:127], v1, s[32:33] offset:3072
  s_add_u32 s30, s30, 4096
  s_addc_u32 s31, s31, 0
  s_add_u32 s32, s32, 4096
  s_addc_u32 s33, s33, 0
  s_waitcnt vmcnt(10) lgkmcnt(4)
  v_mfma_f32_32x32x16_bf16 v[128:143], v[64:67], v[96:99], v[128:143]
  v_mfma_f32_32x32x16_bf16 v[192:207], v[64:67], v[100:103], v[192:207]
  v_mfma_f32_32x32x16_bf16 v[144:159], v[68:71], v[96:99], v[144:159]
  v_mfma_f32_32x32x16_bf16 v[208:223], v[68:71], v[100:103], v[208:223]
  v_mfma_f32_32x32x16_bf16 v[160:175], v[72:75], v[96:99], v[160:175]
  v_mfma_f32_32x32x16_bf16 v[224:239], v[72:75], v[100:103], v[224:239]
  v_mfma_f32_32x32x16_bf16 v[176:191], v[76:79], v[96:99], v[176:191]
  v_mfma_f32_32x32x16_bf16 v[240:255], v[76:79], v[100:103], v[240:255]
  ds_read_b128 v[64:67], v1 offset:8192
  ds_read_b128 v[68:71], v1 offset:9216
  ds_read_b128 v[72:75], v1 offset:10240
  ds_read_b128 v[76:79], v1 offset:11264
  global_load_dwordx4 v[96:99], v1, s[30:31] offset:0
  global_load_dwordx4 v[100:103], v1, s[32:33] offset:0
  s_waitcnt vmcnt(10) lgkmcnt(4)
  v_mfma_f32_32x32x16_bf16 v[128:143], v[80:83], v[104:107], v[128:143]
  v_mfma_f32_32x32x16_bf16 v[192:207], v[80:83], v[108:111], v[192:207]
  v_mfma_f32_32x32x16_bf16 v[144:159], v[84:87], v[104:107], v[144:159]
  v_mfma_f32_32x32x16_bf16 v[208:223], v[84:87], v[108:111], v[208:223]
  v_mfma_f32_32x32x16_bf16 v[160:175], v[88:91], v[104:107], v[160:175]
  v_mfma_f32_32x32x16_bf16 v[224:239], v[88:91], v[108:111], v[224:239]
  v_mfma_f32_32x32x16_bf16 v[176:191], v[92:95], v[104:107], v[176:191]
  v_mfma_f32_32x32x16_bf16 v[240:255], v[92:95], v[108:111], v[240:255]
  ds_read_b128 v[80:83], v1 offset:12288
  ds_read_b128 v[84:87], v1 offset:13312
  ds_read_b128 v[88:91], v1 offset:14336
  ds_read_b128 v[92:95], v1 offset:15360
  global_load_dwordx4 v[104:107], v1, s[30:31] offset:1024
  global_load_dwordx4 v[108:111], v1, s[32:33] offset:1024
  s_waitcnt vmcnt(6) lgkmcnt(4)
  v_mfma_f32_32x32x16_bf16 v[128:143], v[64:67], v[112:115], v[128:143]
  v_mfma_f32_32x32x16_bf16 v[192:207], v[64:67], v[116:119], v[192:207]
  v_mfma_f32_32x32x16_bf16 v[144:159], v[68:71], v[112:115], v[144:159]
  v_mfma_f32_32x32x16_bf16 v[208:223], v[68:71], v[116:119], v[208:223]
  v_mfma_f32_32x32x16_bf16 v[160:175], v[72:75], v[112:115], v[160:175]
  v_mfma_f32_32x32x16_bf16 v[224:239], v[72:75], v[116:119], v[224:239]
  v_mfma_f32_32x32x16_bf16 v[176:191], v[76:79], v[112:115], v[176:191]
  v_mfma_f32_32x32x16_bf16 v[240:255], v[76:79], v[116:119], v[240:255]
  s_waitcnt lgkmcnt(0)
  s_barrier
  ds_read_b128 v[64:67], v1 offset:16384
  ds_read_b128 v[68:71], v1 offset:17408
  ds_read_b128 v[72:75], v1 offset:18432
  ds_read_b128 v[76:79], v1 offset:19456
  s_add_u32 m0, s27, 0
  s_nop 0
  global_load_lds_dwordx4 v1, s[20:21] offset:0
  global_load_lds_dwordx4 v1, s[20:21] offset:1024
  global_load_lds_dwordx4 v1, s[20:21] offset:2048
  global_load_lds_dwordx4 v1, s[20:21] offset:3072
  s_add_u32 s20, s20, 16384
  s_addc_u32 s21, s21, 0
  global_load_dwordx4 v[112:115], v1, s[30:31] offset:2048
  global_load_dwordx4 v[116:119], v1, s[32:33] offset:2048
  s_waitcnt vmcnt(10)
  v_mfma_f32_32x32x16_bf16 v[128:143], v[80:83], v[120:123], v[128:143]
  v_mfma_f32_32x32x16_bf16 v[192:207], v[80:83], v[124:127], v[192:207]
  v_mfma_f32_32x32x16_bf16 v[144:159], v[84:87], v[120:123], v[144:159]
  v_mfma_f32_32x32x16_bf16 v[208:223], v[84:87], v[124:127], v[208:223]
  v_mfma_f32_32x32x16_bf16 v[160:175], v[88:91], v[120:123], v[160:175]
  v_mfma_f32_32x32x16_bf16 v[224:239], v[88:91], v[124:127], v[224:239]
  v_mfma_f32_32x32x16_bf16 v[176:191], v[92:95], v[120:123], v[176:191]
  v_mfma_f32_32x32x16_bf16 v[240:255], v[92:95], v[124:127], v[240:255]
  ds_read_b128 v[80:83], v1 offset:20480
  ds_read_b128 v[84:87], v1 offset:21504
  ds_read_b128 v[88:91], v1 offset:22528
  ds_read_b128 v[92:95], v1 offset:23552
  global_load_dwordx4 v[120:123], v1, s[30:31] offset:3072
  global_load_dwordx4 v[124:127], v1, s[32:33] offset:3072
  s_add_u32 s30, s30, 4096
  s_addc_u32 s31, s31, 0
  s_add_u32 s32, s32, 4096
  s_addc_u32 s33, s33, 0
  s_waitcnt vmcnt(10) lgkmcnt(4)
  v_mfma_f32_32x32x16_bf16 v[128:143], v[64:67], v[96:99], v[128:143]
  v_mfma_f32_32x32x16_bf16 v[192:207], v[64:67], v[100:103], v[192:207]
  v_mfma_f32_32x32x16_bf16 v[144:159], v[68:71], v[96:99], v[144:159]
  v_mfma_f32_32x32x16_bf16 v[208:223], v[68:71], v[100:103], v[208:223]
  v_mfma_f32_32x32x16_bf16 v[160:175], v[72:75], v[96:99], v[160:175]
  v_mfma_f32_32x32x16_bf16 v[224:239], v[72:75], v[100:103], v[224:239]
  v_mfma_f32_32x32x16_bf16 v[176:191], v[76:79], v[96:99], v[176:191]
  v_mfma_f32_32x32x16_bf16 v[240:255], v[76:79], v[100:103], v[240:255]
  ds_read_b128 v[64:67], v1 offset:24576
  ds_read_b128 v[68:71], v1 offset:25600
  ds_read_b128 v[72:75], v1 offset:26624
  ds_read_b128 v[76:79], v1 offset:27648
  global_load_dwordx4 v[96:99], v1, s[30:31] offset:0
  global_load_dwordx4 v[100:103], v1, s[32:33] offset:0
  s_waitcnt vmcnt(10) lgkmcnt(4)
  v_mfma_f32_32x32x16_bf16 v[128:143], v[80:83], v[104:107], v[128:143]
  v_mfma_f32_32x32x16_bf16 v[192:207], v[80:83], v[108:111], v[192:207]
  v_mfma_f32_32x32x16_bf16 v[144:159], v[84:87], v[104:107], v[144:159]
  v_mfma_f32_32x32x16_bf16 v[208:223], v[84:87], v[108:111], v[208:223]
  v_mfma_f32_32x32x16_bf16 v[160:175], v[88:91], v[104:107], v[160:175]
  v_mfma_f32_32x32x16_bf16 v[224:239], v[88:91], v[108:111], v[224:239]
  v_mfma_f32_32x32x16_bf16 v[176:191], v[92:95], v[104:107], v[176:191]
  v_mfma_f32_32x32x16_bf16 v[240:255], v[92:95], v[108:111], v[240:255]
  ds_read_b128 v[80:83], v1 offset:28672
  ds_read_b128 v[84:87], v1 offset:29696
  ds_read_b128 v[88:91], v1 offset:30720
  ds_read_b128 v[92:95], v1 offset:31744
  global_load_dwordx4 v[104:107], v1, s[30:31] offset:1024
  global_load_dwordx4 v[108:111], v1, s[32:33] offset:1024
  s_waitcnt vmcnt(6) lgkmcnt(4)
  v_mfma_f32_32x32x16_bf16 v[128:143], v[64:67], v[112:115], v[128:143]
  v_mfma_f32_32x32x16_bf16 v[192:207], v[64:67], v[116:119], v[192:207]
  v_mfma_f32_32x32x16_bf16 v[144:159], v[68:71], v[112:115], v[144:159]
  v_mfma_f32_32x32x16_bf16 v[208:223], v[68:71], v[116:119], v[208:223]
  v_mfma_f32_32x32x16_bf16 v[160:175], v[72:75], v[112:115], v[160:175]
  v_mfma_f32_32x32x16_bf16 v[224:239], v[72:75], v[116:119], v[224:239]
  v_mfma_f32_32x32x16_bf16 v[176:191], v[76:79], v[112:115], v[176:191]
  v_mfma_f32_32x32x16_bf16 v[240:255], v[76:79], v[116:119], v[240:255]
  s_waitcnt lgkmcnt(0)
  s_barrier
  ds_read_b128 v[64:67], v1 offset:32768
  ds_read_b128 v[68:71], v1 offset:33792
  ds_read_b128 v[72:75], v1 offset:34816
  ds_read_b128 v[76:79], v1 offset:35840
  s_add_u32 m0, s27, 16384
  s_nop 0
  global_load_lds_dwordx4 v1, s[20:21] offset:0
  global_load_lds_dwordx4 v1, s[20:21] offset:1024
  global_load_lds_dwordx4 v1, s[20:21] offset:2048
  global_load_lds_dwordx4 v1, s[20:21] offset:3072
  s_add_u32 s20, s20, 16384
  s_addc_u32 s21, s21, 0
  global_load_dwordx4 v[112:115], v1, s[30:31] offset:2048
  global_load_dwordx4 v[116:119], v1, s[32:33] offset:2048
  s_waitcnt vmcnt(10)
  v_mfma_f32_32x32x16_bf16 v[128:143], v[80:83], v[120:123], v[128:143]
  v_mfma_f32_32x32x16_bf16 v[192:207], v[80:83], v[124:127], v[192:207]
  v_mfma_f32_32x32x16_bf16 v[144:159], v[84:87], v[120:123], v[144:159]
  v_mfma_f32_32x32x16_bf16 v[208:223], v[84:87], v[124:127], v[208:223]
  v_mfma_f32_32x32x16_bf16 v[160:175], v[88:91], v[120:123], v[160:175]
  v_mfma_f32_32x32x16_bf16 v[224:239], v[88:91], v[124:127], v[224:239]
  v_mfma_f32_32x32x16_bf16 v[176:191], v[92:95], v[120:123], v[176:191]
  v_mfma_f32_32x32x16_bf16 v[240:255], v[92:95], v[124:127], v[240:255]
  ds_read_b128 v[80:83], v1 offset:36864
  ds_read_b128 v[84:87], v1 offset:37888
  ds_read_b128 v[88:91], v1 offset:38912
  ds_read_b128 v[92:95], v1 offset:39936
  global_load_dwordx4 v[120:123], v1, s[30:31] offset:3072
  global_load_dwordx4 v[124:127], v1, s[32:33] offset:3072
  s_add_u32 s30, s30, 4096
  s_addc_u32 s31, s31, 0
  s_add_u32 s32, s32, 4096
  s_addc_u32 s33, s33, 0
  s_waitcnt vmcnt(10) lgkmcnt(4)
  v_mfma_f32_32x32x16_bf16 v[128:143], v[64:67], v[96:99], v[128:143]
  v_mfma_f32_32x32x16_bf16 v[192:207], v[64:67], v[100:103], v[192:207]
  v_mfma_f32_32x32x16_bf16 v[144:159], v[68:71], v[96:99], v[144:159]
  v_mfma_f32_32x32x16_bf16 v[208:223], v[68:71], v[100:103], v[208:223]
  v_mfma_f32_32x32x16_bf16 v[160:175], v[72:75], v[96:99], v[160:175]
  v_mfma_f32_32x32x16_bf16 v[224:239], v[72:75], v[100:103], v[224:239]
  v_mfma_f32_32x32x16_bf16 v[176:191], v[76:79], v[96:99], v[176:191]
  v_mfma_f32_32x32x16_bf16 v[240:255], v[76:79], v[100:103], v[240:255]
  ds_read_b128 v[64:67], v1 offset:40960
  ds_read_b128 v[68:71], v1 offset:41984
  ds_read_b128 v[72:75], v1 offset:43008
  ds_read_b128 v[76:79], v1 offset:44032
  global_load_dwordx4 v[96:99], v1, s[30:31] offset:0
  global_load_dwordx4 v[100:103], v1, s[32:33] offset:0
  s_waitcnt vmcnt(10) lgkmcnt(4)
  v_mfma_f32_32x32x16_bf16 v[128:143], v[80:83], v[104:107], v[128:143]
  v_mfma_f32_32x32x16_bf16 v[192:207], v[80:83], v[108:111], v[192:207]
  v_mfma_f32_32x32x16_bf16 v[144:159], v[84:87], v[104:107], v[144:159]
  v_mfma_f32_32x32x16_bf16 v[208:223], v[84:87], v[108:111], v[208:223]
  v_mfma_f32_32x32x16_bf16 v[160:175], v[88:91], v[104:107], v[160:175]
  v_mfma_f32_32x32x16_bf16 v[224:239], v[88:91], v[108:111], v[224:239]
  v_mfma_f32_32x32x16_bf16 v[176:191], v[92:95], v[104:107], v[176:191]
  v_mfma_f32_32x32x16_bf16 v[240:255], v[92:95], v[108:111], v[240:255]
  ds_read_b128 v[80:83], v1 offset:45056
  ds_read_b128 v[84:87], v1 offset:46080
  ds_read_b128 v[88:91], v1 offset:47104
  ds_read_b128 v[92:95], v1 offset:48128
  global_load_dwordx4 v[104:107], v1, s[30:31] offset:1024
  global_load_dwordx4 v[108:111], v1, s[32:33] offset:1024
  s_waitcnt vmcnt(6) lgkmcnt(4)
  v_mfma_f32_32x32x16_bf16 v[128:143], v[64:67], v[112:115], v[128:143]
  v_mfma_f32_32x32x16_bf16 v[192:207], v[64:67], v[116:119], v[192:207]
  v_mfma_f32_32x32x16_bf16 v[144:159], v[68:71], v[112:115], v[144:159]
  v_mfma_f32_32x32x16_bf16 v[208:223], v[68:71], v[116:119], v[208:223]
  v_mfma_f32_32x32x16_bf16 v[160:175], v[72:75], v[112:115], v[160:175]
  v_mfma_f32_32x32x16_bf16 v[224:239], v[72:75], v[116:119], v[224:239]
  v_mfma_f32_32x32x16_bf16 v[176:191], v[76:79], v[112:115], v[176:191]
  v_mfma_f32_32x32x16_bf16 v[240:255], v[76:79], v[116:119], v[240:255]
  s_waitcnt lgkmcnt(0)
  s_barrier
  ds_read_b128 v[64:67], v1 offset:0
  ds_read_b128 v[68:71], v1 offset:1024
  ds_read_b128 v[72:75], v1 offset:2048
  ds_read_b128 v[76:79], v1 offset:3072
  s_add_u32 m0, s27, 32768
  s_nop 0
  global_load_lds_dwordx4 v1, s[20:21] offset:0
  global_load_lds_dwordx4 v1, s[20:21] offset:1024
  global_load_lds_dwordx4 v1, s[20:21] offset:2048
  global_load_lds_dwordx4 v1, s[20:21] offset:3072
  s_add_u32 s20, s20, 16384
  s_addc_u32 s21, s21, 0
  global_load_dwordx4 v[112:115], v1, s[30:31] offset:2048
  global_load_dwordx4 v[116:119], v1, s[32:33] offset:2048
  s_waitcnt vmcnt(10)
  v_mfma_f32_32x32x16_bf16 v[128:143], v[80:83], v[120:123], v[128:143]
  v_mfma_f32_32x32x16_bf16 v[192:207], v[80:83], v[124:127], v[192:207]
  v_mfma_f32_32x32x16_bf16 v[144:159], v[84:87], v[120:123], v[144:159]
  v_mfma_f32_32x32x16_bf16 v[208:223], v[84:87], v[124:127], v[208:223]
  v_mfma_f32_32x32x16_bf16 v[160:175], v[88:91], v[120:123], v[160:175]
  v_mfma_f32_32x32x16_bf16 v[224:239], v[88:91], v[124:127], v[224:239]
  v_mfma_f32_32x32x16_bf16 v[176:191], v[92:95], v[120:123], v[176:191]
  v_mfma_f32_32x32x16_bf16 v[240:255], v[92:95], v[124:127], v[240:255]
  ds_read_b128 v[80:83], v1 offset:4096
  ds_read_b128 v[84:87], v1 offset:5120
  ds_read_b128 v[88:91], v1 offset:6144
  ds_read_b128 v[92:95], v1 offset:7168
  global_load_dwordx4 v[120:123], v1, s[30:31] offset:3072
  global_load_dwordx4 v[124:127], v1, s[32:33] offset:3072
  s_add_u32 s30, s30, 4096
  s_addc_u32 s31, s31, 0
  s_add_u32 s32, s32, 4096
  s_addc_u32 s33, s33, 0
  s_waitcnt vmcnt(10) lgkmcnt(4)
  v_mfma_f32_32x32x16_bf16 v[128:143], v[64:67], v[96:99], v[128:143]
  v_mfma_f32_32x32x16_bf16 v[192:207], v[64:67], v[100:103], v[192:207]
  v_mfma_f32_32x32x16_bf16 v[144:159], v[68:71], v[96:99], v[144:159]
  v_mfma_f32_32x32x16_bf16 v[208:223], v[68:71], v[100:103], v[208:223]
  v_mfma_f32_32x32x16_bf16 v[160:175], v[72:75], v[96:99], v[160:175]
  v_mfma_f32_32x32x16_bf16 v[224:239], v[72:75], v[100:103], v[224:239]
  v_mfma_f32_32x32x16_bf16 v[176:191], v[76:79], v[96:99], v[176:191]
  v_mfma_f32_32x32x16_bf16 v[240:255], v[76:79], v[100:103], v[240:255]
  ds_read_b128 v[64:67], v1 offset:8192
  ds_read_b128 v[68:71], v1 offset:9216
  ds_read_b128 v[72:75], v1 offset:10240
  ds_read_b128 v[76:79], v1 offset:11264
  global_load_dwordx4 v[96:99], v1, s[30:31] offset:0
  global_load_dwordx4 v[100:103], v1, s[32:33] offset:0
  s_waitcnt vmcnt(10) lgkmcnt(4)
  v_mfma_f32_32x32x16_bf16 v[128:143], v[80:83], v[104:107], v[128:143]
  v_mfma_f32_32x32x16_bf16 v[192:207], v[80:83], v[108:111], v[192:207]
  v_mfma_f32_32x32x16_bf16 v[144:159], v[84:87], v[104:107], v[144:159]
  v_mfma_f32_32x32x16_bf16 v[208:223], v[84:87], v[108:111], v[208:223]
  v_mfma_f32_32x32x16_bf16 v[160:175], v[88:91], v[104:107], v[160:175]
  v_mfma_f32_32x32x16_bf16 v[224:239], v[88:91], v[108:111], v[224:239]
  v_mfma_f32_32x32x16_bf16 v[176:191], v[92:95], v[104:107], v[176:191]
  v_mfma_f32_32x32x16_bf16 v[240:255], v[92:95], v[108:111], v[240:255]
  ds_read_b128 v[80:83], v1 offset:12288
  ds_read_b128 v[84:87], v1 offset:13312
  ds_read_b128 v[88:91], v1 offset:14336
  ds_read_b128 v[92:95], v1 offset:15360
  global_load_dwordx4 v[104:107], v1, s[30:31] offset:1024
  global_load_dwordx4 v[108:111], v1, s[32:33] offset:1024
  s_waitcnt vmcnt(6) lgkmcnt(4)
  v_mfma_f32_32x32x16_bf16 v[128:143], v[64:67], v[112:115], v[128:143]
  v_mfma_f32_32x32x16_bf16 v[192:207], v[64:67], v[116:119], v[192:207]
  v_mfma_f32_32x32x16_bf16 v[144:159], v[68:71], v[112:115], v[144:159]
  v_mfma_f32_32x32x16_bf16 v[208:223], v[68:71], v[116:119], v[208:223]
  v_mfma_f32_32x32x16_bf16 v[160:175], v[72:75], v[112:115], v[160:175]
  v_mfma_f32_32x32x16_bf16 v[224:239], v[72:75], v[116:119], v[224:239]
  v_mfma_f32_32x32x16_bf16 v[176:191], v[76:79], v[112:115], v[176:191]
  v_mfma_f32_32x32x16_bf16 v[240:255], v[76:79], v[116:119], v[240:255]
  s_waitcnt lgkmcnt(0)
  s_barrier
  ds_read_b128 v[64:67], v1 offset:16384
  ds_read_b128 v[68:71], v1 offset:17408
  ds_read_b128 v[72:75], v1 offset:18432
  ds_read_b128 v[76:79], v1 offset:19456
  s_add_u32 m0, s27, 0
  s_nop 0
  global_load_lds_dwordx4 v1, s[20:21] offset:0
  global_load_lds_dwordx4 v1, s[20:21] offset:1024
  global_load_lds_dwordx4 v1, s[20:21] offset:2048
  global_load_lds_dwordx4 v1, s[20:21] offset:3072
  s_add_u32 s20, s20, 16384
  s_addc_u32 s21, s21, 0
  global_load_dwordx4 v[112:115], v1, s[30:31] offset:2048
  global_load_dwordx4 v[116:119], v1, s[32:33] offset:2048
  s_waitcnt vmcnt(10)
  v_mfma_f32_32x32x16_bf16 v[128:143], v[80:83], v[120:123], v[128:143]
  v_mfma_f32_32x32x16_bf16 v[192:207], v[80:83], v[124:127], v[192:207]
  v_mfma_f32_32x32x16_bf16 v[144:159], v[84:87], v[120:123], v[144:159]
  v_mfma_f32_32x32x16_bf16 v[208:223], v[84:87], v[124:127], v[208:223]
  v_mfma_f32_32x32x16_bf16 v[160:175], v[88:91], v[120:123], v[160:175]
  v_mfma_f32_32x32x16_bf16 v[224:239], v[88:91], v[124:127], v[224:239]
  v_mfma_f32_32x32x16_bf16 v[176:191], v[92:95], v[120:123], v[176:191]
  v_mfma_f32_32x32x16_bf16 v[240:255], v[92:95], v[124:127], v[240:255]
  ds_read_b128 v[80:83], v1 offset:20480
  ds_read_b128 v[84:87], v1 offset:21504
  ds_read_b128 v[88:91], v1 offset:22528
  ds_read_b128 v[92:95], v1 offset:23552
  global_load_dwordx4 v[120:123], v1, s[30:31] offset:3072
  global_load_dwordx4 v[124:127], v1, s[32:33] offset:3072
  s_add_u32 s30, s30, 4096
  s_addc_u32 s31, s31, 0
  s_add_u32 s32, s32, 4096
  s_addc_u32 s33, s33, 0
  s_waitcnt vmcnt(10) lgkmcnt(4)
  v_mfma_f32_32x32x16_bf16 v[128:143], v[64:67], v[96:99], v[128:143]
  v_mfma_f32_32x32x16_bf16 v[192:207], v[64:67], v[100:103], v[192:207]
  v_mfma_f32_32x32x16_bf16 v[144:159], v[68:71], v[96:99], v[144:159]
  v_mfma_f32_32x32x16_bf16 v[208:223], v[68:71], v[100:103], v[208:223]
  v_mfma_f32_32x32x16_bf16 v[160:175], v[72:75], v[96:99], v[160:175]
  v_mfma_f32_32x32x16_bf16 v[224:239], v[72:75], v[100:103], v[224:239]
  v_mfma_f32_32x32x16_bf16 v[176:191], v[76:79], v[96:99], v[176:191]
  v_mfma_f32_32x32x16_bf16 v[240:255], v[76:79], v[100:103], v[240:255]
  ds_read_b128 v[64:67], v1 offset:24576
  ds_read_b128 v[68:71], v1 offset:25600
  ds_read_b128 v[72:75], v1 offset:26624
  ds_read_b128 v[76:79], v1 offset:27648
  global_load_dwordx4 v[96:99], v1, s[30:31] offset:0
  global_load_dwordx4 v[100:103], v1, s[32:33] offset:0
  s_waitcnt vmcnt(10) lgkmcnt(4)
  v_mfma_f32_32x32x16_bf16 v[128:143], v[80:83], v[104:107], v[128:143]
  v_mfma_f32_32x32x16_bf16 v[192:207], v[80:83], v[108:111], v[192:207]
  v_mfma_f32_32x32x16_bf16 v[144:159], v[84:87], v[104:107], v[144:159]
  v_mfma_f32_32x32x16_bf16 v[208:223], v[84:87], v[108:111], v[208:223]
  v_mfma_f32_32x32x16_bf16 v[160:175], v[88:91], v[104:107], v[160:175]
  v_mfma_f32_32x32x16_bf16 v[224:239], v[88:91], v[108:111], v[224:239]
  v_mfma_f32_32x32x16_bf16 v[176:191], v[92:95], v[104:107], v[176:191]
  v_mfma_f32_32x32x16_bf16 v[240:255], v[92:95], v[108:111], v[240:255]
  ds_read_b128 v[80:83], v1 offset:28672
  ds_read_b128 v[84:87], v1 offset:29696
  ds_read_b128 v[88:91], v1 offset:30720
  ds_read_b128 v[92:95], v1 offset:31744
  global_load_dwordx4 v[104:107], v1, s[30:31] offset:1024
  global_load_dwordx4 v[108:111], v1, s[32:33] offset:1024
  s_waitcnt vmcnt(6) lgkmcnt(4)
  v_mfma_f32_32x32x16_bf16 v[128:143], v[64:67], v[112:115], v[128:143]
  v_mfma_f32_32x32x16_bf16 v[192:207], v[64:67], v[116:119], v[192:207]
  v_mfma_f32_32x32x16_bf16 v[144:159], v[68:71], v[112:115], v[144:159]
  v_mfma_f32_32x32x16_bf16 v[208:223], v[68:71], v[116:119], v[208:223]
  v_mfma_f32_32x32x16_bf16 v[160:175], v[72:75], v[112:115], v[160:175]
  v_mfma_f32_32x32x16_bf16 v[224:239], v[72:75], v[116:119], v[224:239]
  v_mfma_f32_32x32x16_bf16 v[176:191], v[76:79], v[112:115], v[176:191]
  v_mfma_f32_32x32x16_bf16 v[240:255], v[76:79], v[116:119], v[240:255]
  s_waitcnt lgkmcnt(0)
  s_barrier
  ds_read_b128 v[64:67], v1 offset:32768
  ds_read_b128 v[68:71], v1 offset:33792
  ds_read_b128 v[72:75], v1 offset:34816
  ds_read_b128 v[76:79], v1 offset:35840
  global_load_dwordx4 v[112:115], v1, s[30:31] offset:2048
  global_load_dwordx4 v[116:119], v1, s[32:33] offset:2048
  s_waitcnt vmcnt(6)
  v_mfma_f32_32x32x16_bf16 v[128:143], v[80:83], v[120:123], v[128:143]
  v_mfma_f32_32x32x16_bf16 v[192:207], v[80:83], v[124:127], v[192:207]
  v_mfma_f32_32x32x16_bf16 v[144:159], v[84:87], v[120:123], v[144:159]
  v_mfma_f32_32x32x16_bf16 v[208:223], v[84:87], v[124:127], v[208:223]
  v_mfma_f32_32x32x16_bf16 v[160:175], v[88:91], v[120:123], v[160:175]
  v_mfma_f32_32x32x16_bf16 v[224:239], v[88:91], v[124:127], v[224:239]
  v_mfma_f32_32x32x16_bf16 v[176:191], v[92:95], v[120:123], v[176:191]
  v_mfma_f32_32x32x16_bf16 v[240:255], v[92:95], v[124:127], v[240:255]
  ds_read_b128 v[80:83], v1 offset:36864
  ds_read_b128 v[84:87], v1 offset:37888
  ds_read_b128 v[88:91], v1 offset:38912
  ds_read_b128 v[92:95], v1 offset:39936
  global_load_dwordx4 v[120:123], v1, s[30:31] offset:3072
  global_load_dwordx4 v[124:127], v1, s[32:33] offset:3072
  s_add_u32 s30, s30, 4096
  s_addc_u32 s31, s31, 0
  s_add_u32 s32, s32, 4096
  s_addc_u32 s33, s33, 0
  s_waitcnt vmcnt(6) lgkmcnt(4)
  v_mfma_f32_32x32x16_bf16 v[128:143], v[64:67], v[96:99], v[128:143]
  v_mfma_f32_32x32x16_bf16 v[192:207], v[64:67], v[100:103], v[192:207]
  v_mfma_f32_32x32x16_bf16 v[144:159], v[68:71], v[96:99], v[144:159]
  v_mfma_f32_32x32x16_bf16 v[208:223], v[68:71], v[100:103], v[208:223]
  v_mfma_f32_32x32x16_bf16 v[160:175], v[72:75], v[96:99], v[160:175]
  v_mfma_f32_32x32x16_bf16 v[224:239], v[72:75], v[100:103], v[224:239]
  v_mfma_f32_32x32x16_bf16 v[176:191], v[76:79], v[96:99], v[176:191]
  v_mfma_f32_32x32x16_bf16 v[240:255], v[76:79], v[100:103], v[240:255]
  ds_read_b128 v[64:67], v1 offset:40960
  ds_read_b128 v[68:71], v1 offset:41984
  ds_read_b128 v[72:75], v1 offset:43008
  ds_read_b128 v[76:79], v1 offset:44032
  global_load_dwordx4 v[96:99], v1, s[30:31] offset:0
  global_load_dwordx4 v[100:103], v1, s[32:33] offset:0
  s_waitcnt vmcnt(6) lgkmcnt(4)
  v_mfma_f32_32x32x16_bf16 v[128:143], v[80:83], v[104:107], v[128:143]
  v_mfma_f32_32x32x16_bf16 v[192:207], v[80:83], v[108:111], v[192:207]
  v_mfma_f32_32x32x16_bf16 v[144:159], v[84:87], v[104:107], v[144:159]
  v_mfma_f32_32x32x16_bf16 v[208:223], v[84:87], v[108:111], v[208:223]
  v_mfma_f32_32x32x16_bf16 v[160:175], v[88:91], v[104:107], v[160:175]
  v_mfma_f32_32x32x16_bf16 v[224:239], v[88:91], v[108:111], v[224:239]
  v_mfma_f32_32x32x16_bf16 v[176:191], v[92:95], v[104:107], v[176:191]
  v_mfma_f32_32x32x16_bf16 v[240:255], v[92:95], v[108:111], v[240:255]
  ds_read_b128 v[80:83], v1 offset:45056
  ds_read_b128 v[84:87], v1 offset:46080
  ds_read_b128 v[88:91], v1 offset:47104
  ds_read_b128 v[92:95], v1 offset:48128
  global_load_dwordx4 v[104:107], v1, s[30:31] offset:1024
  global_load_dwordx4 v[108:111], v1, s[32:33] offset:1024
  s_waitcnt vmcnt(6) lgkmcnt(4)
  v_mfma_f32_32x32x16_bf16 v[128:143], v[64:67], v[112:115], v[128:143]
  v_mfma_f32_32x32x16_bf16 v[192:207], v[64:67], v[116:119], v[192:207]
  v_mfma_f32_32x32x16_bf16 v[144:159], v[68:71], v[112:115], v[144:159]
  v_mfma_f32_32x32x16_bf16 v[208:223], v[68:71], v[116:119], v[208:223]
  v_mfma_f32_32x32x16_bf16 v[160:175], v[72:75], v[112:115], v[160:175]
  v_mfma_f32_32x32x16_bf16 v[224:239], v[72:75], v[116:119], v[224:239]
  v_mfma_f32_32x32x16_bf16 v[176:191], v[76:79], v[112:115], v[176:191]
  v_mfma_f32_32x32x16_bf16 v[240:255], v[76:79], v[116:119], v[240:255]
  s_waitcnt lgkmcnt(0)
  s_barrier
  ds_read_b128 v[64:67], v1 offset:0
  ds_read_b128 v[68:71], v1 offset:1024
  ds_read_b128 v[72:75], v1 offset:2048
  ds_read_b128 v[76:79], v1 offset:3072
  global_load_dwordx4 v[112:115], v1, s[30:31] offset:2048
  global_load_dwordx4 v[116:119], v1, s[32:33] offset:2048
  s_waitcnt vmcnt(6)
  v_mfma_f32_32x32x16_bf16 v[128:143], v[80:83], v[120:123], v[128:143]
  v_mfma_f32_32x32x16_bf16 v[192:207], v[80:83], v[124:127], v[192:207]
  v_mfma_f32_32x32x16_bf16 v[144:159], v[84:87], v[120:123], v[144:159]
  v_mfma_f32_32x32x16_bf16 v[208:223], v[84:87], v[124:127], v[208:223]
  v_mfma_f32_32x32x16_bf16 v[160:175], v[88:91], v[120:123], v[160:175]
  v_mfma_f32_32x32x16_bf16 v[224:239], v[88:91], v[124:127], v[224:239]
  v_mfma_f32_32x32x16_bf16 v[176:191], v[92:95], v[120:123], v[176:191]
  v_mfma_f32_32x32x16_bf16 v[240:255], v[92:95], v[124:127], v[240:255]
  ds_read_b128 v[80:83], v1 offset:4096
  ds_read_b128 v[84:87], v1 offset:5120
  ds_read_b128 v[88:91], v1 offset:6144
  ds_read_b128 v[92:95], v1 offset:7168
  global_load_dwordx4 v[120:123], v1, s[30:31] offset:3072
  global_load_dwordx4 v[124:127], v1, s[32:33] offset:3072
  s_add_u32 s30, s30, 4096
  s_addc_u32 s31, s31, 0
  s_add_u32 s32, s32, 4096
  s_addc_u32 s33, s33, 0
  s_waitcnt vmcnt(6) lgkmcnt(4)
  v_mfma_f32_32x32x16_bf16 v[128:143], v[64:67], v[96:99], v[128:143]
  v_mfma_f32_32x32x16_bf16 v[192:207], v[64:67], v[100:103], v[192:207]
  v_mfma_f32_32x32x16_bf16 v[144:159], v[68:71], v[96:99], v[144:159]
  v_mfma_f32_32x32x16_bf16 v[208:223], v[68:71], v[100:103], v[208:223]
  v_mfma_f32_32x32x16_bf16 v[160:175], v[72:75], v[96:99], v[160:175]
  v_mfma_f32_32x32x16_bf16 v[224:239], v[72:75], v[100:103], v[224:239]
  v_mfma_f32_32x32x16_bf16 v[176:191], v[76:79], v[96:99], v[176:191]
  v_mfma_f32_32x32x16_bf16 v[240:255], v[76:79], v[100:103], v[240:255]
  ds_read_b128 v[64:67], v1 offset:8192
  ds_read_b128 v[68:71], v1 offset:9216
  ds_read_b128 v[72:75], v1 offset:10240
  ds_read_b128 v[76:79], v1 offset:11264
  s_waitcnt vmcnt(4) lgkmcnt(4)
  v_mfma_f32_32x32x16_bf16 v[128:143], v[80:83], v[104:107], v[128:143]
  v_mfma_f32_32x32x16_bf16 v[192:207], v[80:83], v[108:111], v[192:207]
  v_mfma_f32_32x32x16_bf16 v[144:159], v[84:87], v[104:107], v[144:159]
  v_mfma_f32_32x32x16_bf16 v[208:223], v[84:87], v[108:111], v[208:223]
  v_mfma_f32_32x32x16_bf16 v[160:175], v[88:91], v[104:107], v[160:175]
  v_mfma_f32_32x32x16_bf16 v[224:239], v[88:91], v[108:111], v[224:239]
  v_mfma_f32_32x32x16_bf16 v[176:191], v[92:95], v[104:107], v[176:191]
  v_mfma_f32_32x32x16_bf16 v[240:255], v[92:95], v[108:111], v[240:255]
  ds_read_b128 v[80:83], v1 offset:12288
  ds_read_b128 v[84:87], v1 offset:13312
  ds_read_b128 v[88:91], v1 offset:14336
  ds_read_b128 v[92:95], v1 offset:15360
  s_waitcnt vmcnt(2) lgkmcnt(4)
  v_mfma_f32_32x32x16_bf16 v[128:143], v[64:67], v[112:115], v[128:143]
  v_mfma_f32_32x32x16_bf16 v[192:207], v[64:67], v[116:119], v[192:207]
  v_mfma_f32_32x32x16_bf16 v[144:159], v[68:71], v[112:115], v[144:159]
  v_mfma_f32_32x32x16_bf16 v[208:223], v[68:71], v[116:119], v[208:223]
  v_mfma_f32_32x32x16_bf16 v[160:175], v[72:75], v[112:115], v[160:175]
  v_mfma_f32_32x32x16_bf16 v[224:239], v[72:75], v[116:119], v[224:239]
  v_mfma_f32_32x32x16_bf16 v[176:191], v[76:79], v[112:115], v[176:191]
  v_mfma_f32_32x32x16_bf16 v[240:255], v[76:79], v[116:119], v[240:255]
  s_waitcnt vmcnt(0) lgkmcnt(0)
  v_mfma_f32_32x32x16_bf16 v[128:143], v[80:83], v[120:123], v[128:143]
  v_mfma_f32_32x32x16_bf16 v[192:207], v[80:83], v[124:127], v[192:207]
  v_mfma_f32_32x32x16_bf16 v[144:159], v[84:87], v[120:123], v[144:159]
  v_mfma_f32_32x32x16_bf16 v[208:223], v[84:87], v[124:127], v[208:223]
  v_mfma_f32_32x32x16_bf16 v[160:175], v[88:91], v[120:123], v[160:175]
  v_mfma_f32_32x32x16_bf16 v[224:239], v[88:91], v[124:127], v[224:239]
  v_mfma_f32_32x32x16_bf16 v[176:191], v[92:95], v[120:123], v[176:191]
  v_mfma_f32_32x32x16_bf16 v[240:255], v[92:95], v[124:127], v[240:255]
  s_lshl_b32 s22, s17, 12
  s_mul_i32 s29, s28, 151552
  s_add_u32 s29, s29, s22
  s_add_u32 s29, s29, 5611520
  s_add_u32 s30, s12, s29
  s_addc_u32 s31, s13, 0
  s_mov_b32 s36, 0xbfb8aa3b
  s_mov_b32 s37, 0xbfb8aa3b
  s_mov_b32 s38, 1.0
  s_mov_b32 s39, 1.0
  s_nop 7
  v_pk_mul_f32 v[96:97], v[128:129], s[36:37]
  v_pk_mul_f32 v[98:99], v[130:131], s[36:37]
  v_pk_mul_f32 v[100:101], v[132:133], s[36:37]
  v_pk_mul_f32 v[102:103], v[134:135], s[36:37]
  v_exp_f32 v96, v96
  v_exp_f32 v97, v97
  v_exp_f32 v98, v98
  v_exp_f32 v99, v99
  v_exp_f32 v100, v100
  v_exp_f32 v101, v101
  v_exp_f32 v102, v102
  v_exp_f32 v103, v103
  v_pk_mul_f32 v[128:129], v[128:129], v[160:161]
  v_pk_mul_f32 v[130:131], v[130:131], v[162:163]
  v_pk_mul_f32 v[132:133], v[132:133], v[164:165]
  v_pk_mul_f32 v[134:135], v[134:135], v[166:167]
  v_pk_add_f32 v[96:97], v[96:97], s[38:39]
  v_pk_add_f32 v[98:99], v[98:99], s[38:39]
  v_pk_add_f32 v[100:101], v[100:101], s[38:39]
  v_pk_add_f32 v[102:103], v[102:103], s[38:39]
  v_rcp_f32 v96, v96
  v_rcp_f32 v97, v97
  v_rcp_f32 v98, v98
  v_rcp_f32 v99, v99
  v_rcp_f32 v100, v100
  v_rcp_f32 v101, v101
  v_rcp_f32 v102, v102
  v_rcp_f32 v103, v103
  s_nop 0
  v_pk_mul_f32 v[128:129], v[128:129], v[96:97]
  v_pk_mul_f32 v[130:131], v[130:131], v[98:99]
  v_pk_mul_f32 v[132:133], v[132:133], v[100:101]
  v_pk_mul_f32 v[134:135], v[134:135], v[102:103]
  v_pk_mul_f32 v[104:105], v[136:137], s[36:37]
  v_pk_mul_f32 v[106:107], v[138:139], s[36:37]
  v_pk_mul_f32 v[108:109], v[140:141], s[36:37]
  v_pk_mul_f32 v[110:111], v[142:143], s[36:37]
  v_exp_f32 v104, v104
  v_exp_f32 v105, v105
  v_exp_f32 v106, v106
  v_exp_f32 v107, v107
  v_exp_f32 v108, v108
  v_exp_f32 v109, v109
  v_exp_f32 v110, v110
  v_exp_f32 v111, v111
  v_pk_mul_f32 v[136:137], v[136:137], v[168:169]
  v_pk_mul_f32 v[138:139], v[138:139], v[170:171]
  v_pk_mul_f32 v[140:141], v[140:141], v[172:173]
  v_pk_mul_f32 v[142:143], v[142:143], v[174:175]
  v_pk_add_f32 v[104:105], v[104:105], s[38:39]
  v_pk_add_f32 v[106:107], v[106:107], s[38:39]
  v_pk_add_f32 v[108:109], v[108:109], s[38:39]
  v_pk_add_f32 v[110:111], v[110:111], s[38:39]
  v_rcp_f32 v104, v104
  v_rcp_f32 v105, v105
  v_rcp_f32 v106, v106
  v_rcp_f32 v107, v107
  v_rcp_f32 v108, v108
  v_rcp_f32 v109, v109
  v_rcp_f32 v110, v110
  v_rcp_f32 v111, v111
  s_nop 0
  v_pk_mul_f32 v[136:137], v[136:137], v[104:105]
  v_pk_mul_f32 v[138:139], v[138:139], v[106:107]
  v_pk_mul_f32 v[140:141], v[140:141], v[108:109]
  v_pk_mul_f32 v[142:143], v[142:143], v[110:111]
  v_cvt_pk_bf16_f32 v64, v128, v129
  v_cvt_pk_bf16_f32 v65, v130, v131
  v_cvt_pk_bf16_f32 v66, v132, v133
  v_cvt_pk_bf16_f32 v67, v134, v135
  v_cvt_pk_bf16_f32 v68, v136, v137
  v_cvt_pk_bf16_f32 v69, v138, v139
  v_cvt_pk_bf16_f32 v70, v140, v141
  v_cvt_pk_bf16_f32 v71, v142, v143
  v_add_u32 v4, 0, v1
  global_store_dwordx4 v4, v[64:67], s[30:31]
  global_store_dwordx4 v4, v[68:71], s[30:31] offset:1024
  v_pk_mul_f32 v[96:97], v[192:193], s[36:37]
  v_pk_mul_f32 v[98:99], v[194:195], s[36:37]
  v_pk_mul_f32 v[100:101], v[196:197], s[36:37]
  v_pk_mul_f32 v[102:103], v[198:199], s[36:37]
  v_exp_f32 v96, v96
  v_exp_f32 v97, v97
  v_exp_f32 v98, v98
  v_exp_f32 v99, v99
  v_exp_f32 v100, v100
  v_exp_f32 v101, v101
  v_exp_f32 v102, v102
  v_exp_f32 v103, v103
  v_pk_mul_f32 v[192:193], v[192:193], v[224:225]
  v_pk_mul_f32 v[194:195], v[194:195], v[226:227]
  v_pk_mul_f32 v[196:197], v[196:197], v[228:229]
  v_pk_mul_f32 v[198:199], v[198:199], v[230:231]
  v_pk_add_f32 v[96:97], v[96:97], s[38:39]
  v_pk_add_f32 v[98:99], v[98:99], s[38:39]
  v_pk_add_f32 v[100:101], v[100:101], s[38:39]
  v_pk_add_f32 v[102:103], v[102:103], s[38:39]
  v_rcp_f32 v96, v96
  v_rcp_f32 v97, v97
  v_rcp_f32 v98, v98
  v_rcp_f32 v99, v99
  v_rcp_f32 v100, v100
  v_rcp_f32 v101, v101
  v_rcp_f32 v102, v102
  v_rcp_f32 v103, v103
  s_nop 0
  v_pk_mul_f32 v[192:193], v[192:193], v[96:97]
  v_pk_mul_f32 v[194:195], v[194:195], v[98:99]
  v_pk_mul_f32 v[196:197], v[196:197], v[100:101]
  v_pk_mul_f32 v[198:199], v[198:199], v[102:103]
  v_pk_mul_f32 v[104:105], v[200:201], s[36:37]
  v_pk_mul_f32 v[106:107], v[202:203], s[36:37]
  v_pk_mul_f32 v[108:109], v[204:205], s[36:37]
  v_pk_mul_f32 v[110:111], v[206:207], s[36:37]
  v_exp_f32 v104, v104
  v_exp_f32 v105, v105
  v_exp_f32 v106, v106
  v_exp_f32 v107, v107
  v_exp_f32 v108, v108
  v_exp_f32 v109, v109
  v_exp_f32 v110, v110
  v_exp_f32 v111, v111
  v_pk_mul_f32 v[200:201], v[200:201], v[232:233]
  v_pk_mul_f32 v[202:203], v[202:203], v[234:235]
  v_pk_mul_f32 v[204:205], v[204:205], v[236:237]
  v_pk_mul_f32 v[206:207], v[206:207], v[238:239]
  v_pk_add_f32 v[104:105], v[104:105], s[38:39]
  v_pk_add_f32 v[106:107], v[106:107], s[38:39]
  v_pk_add_f32 v[108:109], v[108:109], s[38:39]
  v_pk_add_f32 v[110:111], v[110:111], s[38:39]
  v_rcp_f32 v104, v104
  v_rcp_f32 v105, v105
  v_rcp_f32 v106, v106
  v_rcp_f32 v107, v107
  v_rcp_f32 v108, v108
  v_rcp_f32 v109, v109
  v_rcp_f32 v110, v110
  v_rcp_f32 v111, v111
  s_nop 0
  v_pk_mul_f32 v[200:201], v[200:201], v[104:105]
  v_pk_mul_f32 v[202:203], v[202:203], v[106:107]
  v_pk_mul_f32 v[204:205], v[204:205], v[108:109]
  v_pk_mul_f32 v[206:207], v[206:207], v[110:111]
  v_cvt_pk_bf16_f32 v80, v192, v193
  v_cvt_pk_bf16_f32 v81, v194, v195
  v_cvt_pk_bf16_f32 v82, v196, v197
  v_cvt_pk_bf16_f32 v83, v198, v199
  v_cvt_pk_bf16_f32 v84, v200, v201
  v_cvt_pk_bf16_f32 v85, v202, v203
  v_cvt_pk_bf16_f32 v86, v204, v205
  v_cvt_pk_bf16_f32 v87, v206, v207
  v_add_u32 v6, 151552, v1
  global_store_dwordx4 v6, v[80:83], s[30:31]
  global_store_dwordx4 v6, v[84:87], s[30:31] offset:1024
  v_pk_mul_f32 v[96:97], v[144:145], s[36:37]
  v_pk_mul_f32 v[98:99], v[146:147], s[36:37]
  v_pk_mul_f32 v[100:101], v[148:149], s[36:37]
  v_pk_mul_f32 v[102:103], v[150:151], s[36:37]
  v_exp_f32 v96, v96
  v_exp_f32 v97, v97
  v_exp_f32 v98, v98
  v_exp_f32 v99, v99
  v_exp_f32 v100, v100
  v_exp_f32 v101, v101
  v_exp_f32 v102, v102
  v_exp_f32 v103, v103
  v_pk_mul_f32 v[144:145], v[144:145], v[176:177]
  v_pk_mul_f32 v[146:147], v[146:147], v[178:179]
  v_pk_mul_f32 v[148:149], v[148:149], v[180:181]
  v_pk_mul_f32 v[150:151], v[150:151], v[182:183]
  v_pk_add_f32 v[96:97], v[96:97], s[38:39]
  v_pk_add_f32 v[98:99], v[98:99], s[38:39]
  v_pk_add_f32 v[100:101], v[100:101], s[38:39]
  v_pk_add_f32 v[102:103], v[102:103], s[38:39]
  v_rcp_f32 v96, v96
  v_rcp_f32 v97, v97
  v_rcp_f32 v98, v98
  v_rcp_f32 v99, v99
  v_rcp_f32 v100, v100
  v_rcp_f32 v101, v101
  v_rcp_f32 v102, v102
  v_rcp_f32 v103, v103
  s_nop 0
  v_pk_mul_f32 v[144:145], v[144:145], v[96:97]
  v_pk_mul_f32 v[146:147], v[146:147], v[98:99]
  v_pk_mul_f32 v[148:149], v[148:149], v[100:101]
  v_pk_mul_f32 v[150:151], v[150:151], v[102:103]
  v_pk_mul_f32 v[104:105], v[152:153], s[36:37]
  v_pk_mul_f32 v[106:107], v[154:155], s[36:37]
  v_pk_mul_f32 v[108:109], v[156:157], s[36:37]
  v_pk_mul_f32 v[110:111], v[158:159], s[36:37]
  v_exp_f32 v104, v104
  v_exp_f32 v105, v105
  v_exp_f32 v106, v106
  v_exp_f32 v107, v107
  v_exp_f32 v108, v108
  v_exp_f32 v109, v109
  v_exp_f32 v110, v110
  v_exp_f32 v111, v111
  v_pk_mul_f32 v[152:153], v[152:153], v[184:185]
  v_pk_mul_f32 v[154:155], v[154:155], v[186:187]
  v_pk_mul_f32 v[156:157], v[156:157], v[188:189]
  v_pk_mul_f32 v[158:159], v[158:159], v[190:191]
  v_pk_add_f32 v[104:105], v[104:105], s[38:39]
  v_pk_add_f32 v[106:107], v[106:107], s[38:39]
  v_pk_add_f32 v[108:109], v[108:109], s[38:39]
  v_pk_add_f32 v[110:111], v[110:111], s[38:39]
  v_rcp_f32 v104, v104
  v_rcp_f32 v105, v105
  v_rcp_f32 v106, v106
  v_rcp_f32 v107, v107
  v_rcp_f32 v108, v108
  v_rcp_f32 v109, v109
  v_rcp_f32 v110, v110
  v_rcp_f32 v111, v111
  s_nop 0
  v_pk_mul_f32 v[152:153], v[152:153], v[104:105]
  v_pk_mul_f32 v[154:155], v[154:155], v[106:107]
  v_pk_mul_f32 v[156:157], v[156:157], v[108:109]
  v_pk_mul_f32 v[158:159], v[158:159], v[110:111]
  v_cvt_pk_bf16_f32 v72, v144, v145
  v_cvt_pk_bf16_f32 v73, v146, v147
  v_cvt_pk_bf16_f32 v74, v148, v149
  v_cvt_pk_bf16_f32 v75, v150, v151
  v_cvt_pk_bf16_f32 v76, v152, v153
  v_cvt_pk_bf16_f32 v77, v154, v155
  v_cvt_pk_bf16_f32 v78, v156, v157
  v_cvt_pk_bf16_f32 v79, v158, v159
  v_add_u32 v5, 2048, v1
  global_store_dwordx4 v5, v[72:75], s[30:31]
  global_store_dwordx4 v5, v[76:79], s[30:31] offset:1024
  v_pk_mul_f32 v[96:97], v[208:209], s[36:37]
  v_pk_mul_f32 v[98:99], v[210:211], s[36:37]
  v_pk_mul_f32 v[100:101], v[212:213], s[36:37]
  v_pk_mul_f32 v[102:103], v[214:215], s[36:37]
  v_exp_f32 v96, v96
  v_exp_f32 v97, v97
  v_exp_f32 v98, v98
  v_exp_f32 v99, v99
  v_exp_f32 v100, v100
  v_exp_f32 v101, v101
  v_exp_f32 v102, v102
  v_exp_f32 v103, v103
  v_pk_mul_f32 v[208:209], v[208:209], v[240:241]
  v_pk_mul_f32 v[210:211], v[210:211], v[242:243]
  v_pk_mul_f32 v[212:213], v[212:213], v[244:245]
  v_pk_mul_f32 v[214:215], v[214:215], v[246:247]
  v_pk_add_f32 v[96:97], v[96:97], s[38:39]
  v_pk_add_f32 v[98:99], v[98:99], s[38:39]
  v_pk_add_f32 v[100:101], v[100:101], s[38:39]
  v_pk_add_f32 v[102:103], v[102:103], s[38:39]
  v_rcp_f32 v96, v96
  v_rcp_f32 v97, v97
  v_rcp_f32 v98, v98
  v_rcp_f32 v99, v99
  v_rcp_f32 v100, v100
  v_rcp_f32 v101, v101
  v_rcp_f32 v102, v102
  v_rcp_f32 v103, v103
  s_nop 0
  v_pk_mul_f32 v[208:209], v[208:209], v[96:97]
  v_pk_mul_f32 v[210:211], v[210:211], v[98:99]
  v_pk_mul_f32 v[212:213], v[212:213], v[100:101]
  v_pk_mul_f32 v[214:215], v[214:215], v[102:103]
  v_pk_mul_f32 v[104:105], v[216:217], s[36:37]
  v_pk_mul_f32 v[106:107], v[218:219], s[36:37]
  v_pk_mul_f32 v[108:109], v[220:221], s[36:37]
  v_pk_mul_f32 v[110:111], v[222:223], s[36:37]
  v_exp_f32 v104, v104
  v_exp_f32 v105, v105
  v_exp_f32 v106, v106
  v_exp_f32 v107, v107
  v_exp_f32 v108, v108
  v_exp_f32 v109, v109
  v_exp_f32 v110, v110
  v_exp_f32 v111, v111
  v_pk_mul_f32 v[216:217], v[216:217], v[248:249]
  v_pk_mul_f32 v[218:219], v[218:219], v[250:251]
  v_pk_mul_f32 v[220:221], v[220:221], v[252:253]
  v_pk_mul_f32 v[222:223], v[222:223], v[254:255]
  v_pk_add_f32 v[104:105], v[104:105], s[38:39]
  v_pk_add_f32 v[106:107], v[106:107], s[38:39]
  v_pk_add_f32 v[108:109], v[108:109], s[38:39]
  v_pk_add_f32 v[110:111], v[110:111], s[38:39]
  v_rcp_f32 v104, v104
  v_rcp_f32 v105, v105
  v_rcp_f32 v106, v106
  v_rcp_f32 v107, v107
  v_rcp_f32 v108, v108
  v_rcp_f32 v109, v109
  v_rcp_f32 v110, v110
  v_rcp_f32 v111, v111
  s_nop 0
  v_pk_mul_f32 v[216:217], v[216:217], v[104:105]
  v_pk_mul_f32 v[218:219], v[218:219], v[106:107]
  v_pk_mul_f32 v[220:221], v[220:221], v[108:109]
  v_pk_mul_f32 v[222:223], v[222:223], v[110:111]
  v_cvt_pk_bf16_f32 v88, v208, v209
  v_cvt_pk_bf16_f32 v89, v210, v211
  v_cvt_pk_bf16_f32 v90, v212, v213
  v_cvt_pk_bf16_f32 v91, v214, v215
  v_cvt_pk_bf16_f32 v92, v216, v217
  v_cvt_pk_bf16_f32 v93, v218, v219
  v_cvt_pk_bf16_f32 v94, v220, v221
  v_cvt_pk_bf16_f32 v95, v222, v223
  v_add_u32 v7, 153600, v1
  global_store_dwordx4 v7, v[88:91], s[30:31]
  global_store_dwordx4 v7, v[92:95], s[30:31] offset:1024
  s_lshl_b32 s47, s16, 2
  s_add_u32 s47, s47, 0
L_gu_exit:
  s_endpgm
L_kf_attgu_kernel_end:
  s_endpgm
.globl k3_out_kernel
.p2align 8
.type k3_out_kernel,@function
k3_out_kernel:
  s_cmp_ge_u32 s2, 256
  s_cbranch_scc1 L_k3_out_kernel_end
  s_setprio 0
  s_load_dwordx2 s[4:5], s[0:1], 0
  s_load_dwordx4 s[8:11], s[0:1], 72
  s_load_dwordx2 s[12:13], s[0:1], 88
  v_mbcnt_lo_u32_b32 v1, -1, 0
  v_mbcnt_hi_u32_b32 v1, -1, v1
  v_lshrrev_b32 v2, 6, v0
  s_nop 0
  v_readfirstlane_b32 s3, v2
  s_and_b32 s14, s2, 7
  s_lshr_b32 s15, s2, 3
  s_and_b32 s16, s14, 1
  s_lshl_b32 s16, s16, 2
  s_and_b32 s17, s15, 3
  s_add_u32 s17, s16, s17
  s_lshr_b32 s16, s14, 1
  s_lshl_b32 s16, s16, 3
  s_lshr_b32 s18, s15, 2
  s_add_u32 s16, s16, s18
  s_mul_i32 s18, s17, 160
  v_lshlrev_b32 v14, 4, v1
  v_add_u32 v15, 40960, v14
  v_lshrrev_b32 v5, 5, v1
  v_lshlrev_b32 v5, 10, v5
  v_bfe_u32 v6, v1, 4, 1
  v_lshl_add_u32 v5, v6, 9, v5
  v_and_b32 v7, 15, v1
  v_lshl_add_u32 v5, v7, 4, v5
  s_and_b32 s21, s3, 1
  s_lshl_b32 s21, s21, 8
  v_add_u32 v12, s21, v5
  s_lshl_b32 s21, s16, 1
  s_lshr_b32 s22, s3, 1
  s_add_u32 s21, s21, s22
  s_mul_i32 s21, s21, 151552
  s_add_u32 s21, s21, 5570560
  s_mul_i32 s25, s3, 3072
  s_min_u32 s25, s25, 8192
  s_mul_i32 s26, s17, 378880
  s_add_u32 s26, s26, s25
  s_add_u32 s26, s26, 21004288
  v_and_b32 v2, 15, v1
  s_lshl_b32 s29, s16, 6
  s_lshl_b32 s30, s3, 4
  s_add_u32 s29, s29, s30
  v_add_u32 v2, s29, v2
  v_mul_u32_u24 v2, 1280, v2
  v_lshrrev_b32 v3, 4, v1
  v_lshl_add_u32 v2, v3, 3, v2
  v_add_u32 v2, s18, v2
  s_lshr_b32 s47, s16, 2
  s_lshl_b32 s47, s47, 2
  s_add_u32 s47, s47, 0
  s_lshl_b32 s48, s16, 2
  s_add_u32 s48, s48, 32
  s_waitcnt lgkmcnt(0)
  s_mov_b32 s44, s10
  s_mov_b32 s45, s11
  s_add_u32 s34, s12, s21
  s_addc_u32 s35, s13, 0
  s_add_u32 s22, s34, 40960
  s_addc_u32 s23, s35, 0
  s_add_u32 s26, s12, s26
  s_addc_u32 s27, s13, 0
  s_add_u32 m0, s25, 0
  s_cmp_ge_u32 s3, 2
  s_cbranch_scc1 L_ow69
  global_load_lds_dwordx4 v14, s[26:27] offset:2048
L_ow69:
  global_load_lds_dwordx4 v14, s[26:27]
  global_load_lds_dwordx4 v14, s[26:27] offset:1024
  s_add_u32 s26, s26, 10240
  s_addc_u32 s27, s27, 0
  global_load_dwordx4 v[176:179], v12, s[22:23]
  global_load_dwordx4 v[180:183], v12, s[22:23] offset:2048
  s_add_u32 s22, s22, 4096
  s_addc_u32 s23, s23, 0
  s_add_u32 m0, s25, 10240
  s_cmp_ge_u32 s3, 2
  s_cbranch_scc1 L_ow82
  global_load_lds_dwordx4 v14, s[26:27] offset:2048
L_ow82:
  global_load_lds_dwordx4 v14, s[26:27]
  global_load_lds_dwordx4 v14, s[26:27] offset:1024
  s_add_u32 s26, s26, 10240
  s_addc_u32 s27, s27, 0
  global_load_dwordx4 v[184:187], v12, s[22:23]
  global_load_dwordx4 v[188:191], v12, s[22:23] offset:2048
  s_add_u32 s22, s22, 4096
  s_addc_u32 s23, s23, 0
  s_add_u32 m0, s25, 20480
  s_cmp_ge_u32 s3, 2
  s_cbranch_scc1 L_ow95
  global_load_lds_dwordx4 v14, s[26:27] offset:2048
L_ow95:
  global_load_lds_dwordx4 v14, s[26:27]
  global_load_lds_dwordx4 v14, s[26:27] offset:1024
  s_add_u32 s26, s26, 10240
  s_addc_u32 s27, s27, 0
  global_load_dwordx4 v[192:195], v12, s[22:23]
  global_load_dwordx4 v[196:199], v12, s[22:23] offset:2048
  s_add_u32 s22, s22, 4096
  s_addc_u32 s23, s23, 0
  s_add_u32 m0, s25, 30720
  s_cmp_ge_u32 s3, 2
  s_cbranch_scc1 L_ow108
  global_load_lds_dwordx4 v14, s[26:27] offset:2048
L_ow108:
  global_load_lds_dwordx4 v14, s[26:27]
  global_load_lds_dwordx4 v14, s[26:27] offset:1024
  s_add_u32 s26, s26, 10240
  s_addc_u32 s27, s27, 0
  global_load_dwordx4 v[200:203], v12, s[22:23]
  global_load_dwordx4 v[204:207], v12, s[22:23] offset:2048
  s_add_u32 s22, s22, 4096
  s_addc_u32 s23, s23, 0
  s_add_u32 m0, s25, 40960
  s_cmp_ge_u32 s3, 2
  s_cbranch_scc1 L_ow121
  global_load_lds_dwordx4 v14, s[26:27] offset:2048
L_ow121:
  global_load_lds_dwordx4 v14, s[26:27]
  global_load_lds_dwordx4 v14, s[26:27] offset:1024
  s_add_u32 s26, s26, 10240
  s_addc_u32 s27, s27, 0
  global_load_dwordx4 v[208:211], v12, s[22:23]
  global_load_dwordx4 v[212:215], v12, s[22:23] offset:2048
  s_add_u32 s22, s22, 4096
  s_addc_u32 s23, s23, 0
  s_add_u32 m0, s25, 51200
  s_cmp_ge_u32 s3, 2
  s_cbranch_scc1 L_ow134
  global_load_lds_dwordx4 v14, s[26:27] offset:2048
L_ow134:
  global_load_lds_dwordx4 v14, s[26:27]
  global_load_lds_dwordx4 v14, s[26:27] offset:1024
  s_add_u32 s26, s26, 10240
  s_addc_u32 s27, s27, 0
  global_load_dwordx4 v[216:219], v12, s[22:23]
  global_load_dwordx4 v[220:223], v12, s[22:23] offset:2048
  s_add_u32 s22, s22, 4096
  s_addc_u32 s23, s23, 0
  global_load_dwordx4 v[224:227], v12, s[22:23]
  global_load_dwordx4 v[228:231], v12, s[22:23] offset:2048
  s_add_u32 s22, s22, 4096
  s_addc_u32 s23, s23, 0
  global_load_dwordx4 v[232:235], v12, s[22:23]
  global_load_dwordx4 v[236:239], v12, s[22:23] offset:2048
  s_add_u32 s22, s22, 4096
  s_addc_u32 s23, s23, 0
  global_load_dwordx2 v[20:21], v2, s[4:5] offset:0
  global_load_dwordx2 v[22:23], v2, s[4:5] offset:32
  global_load_dwordx2 v[24:25], v2, s[4:5] offset:64
  global_load_dwordx2 v[26:27], v2, s[4:5] offset:96
  global_load_dwordx2 v[28:29], v2, s[4:5] offset:128
  s_waitcnt vmcnt(31)
  s_barrier
  ds_read_b128 v[96:99], v14 offset:0
  ds_read_b128 v[100:103], v14 offset:1024
  ds_read_b128 v[104:107], v14 offset:2048
  ds_read_b128 v[108:111], v14 offset:3072
  ds_read_b128 v[112:115], v14 offset:4096
  ds_read_b128 v[116:119], v14 offset:5120
  ds_read_b128 v[120:123], v14 offset:6144
  ds_read_b128 v[124:127], v14 offset:7168
  ds_read_b128 v[128:131], v14 offset:8192
  ds_read_b128 v[132:135], v14 offset:9216
  s_waitcnt vmcnt(27) lgkmcnt(0)
  s_barrier
  ds_read_b128 v[136:139], v14 offset:10240
  ds_read_b128 v[140:143], v14 offset:11264
  ds_read_b128 v[144:147], v14 offset:12288
  ds_read_b128 v[148:151], v14 offset:13312
  ds_read_b128 v[152:155], v14 offset:14336
  ds_read_b128 v[156:159], v14 offset:15360
  ds_read_b128 v[160:163], v14 offset:16384
  ds_read_b128 v[164:167], v14 offset:17408
  ds_read_b128 v[168:171], v14 offset:18432
  ds_read_b128 v[172:175], v14 offset:19456
  s_add_u32 m0, s25, 61440
  s_cmp_ge_u32 s3, 2
  s_cbranch_scc1 L_ow184
  global_load_lds_dwordx4 v14, s[26:27] offset:2048
L_ow184:
  global_load_lds_dwordx4 v14, s[26:27]
  global_load_lds_dwordx4 v14, s[26:27] offset:1024
  s_add_u32 s26, s26, 10240
  s_addc_u32 s27, s27, 0
  v_mfma_f32_16x16x32_bf16 v[64:67], v[96:99], v[176:179], 0
  v_mfma_f32_16x16x32_bf16 v[68:71], v[100:103], v[176:179], 0
  v_mfma_f32_16x16x32_bf16 v[72:75], v[104:107], v[176:179], 0
  v_mfma_f32_16x16x32_bf16 v[76:79], v[108:111], v[176:179], 0
  v_mfma_f32_16x16x32_bf16 v[80:83], v[112:115], v[176:179], 0
  v_mfma_f32_16x16x32_bf16 v[64:67], v[116:119], v[180:183], v[64:67]
  v_mfma_f32_16x16x32_bf16 v[68:71], v[120:123], v[180:183], v[68:71]
  v_mfma_f32_16x16x32_bf16 v[72:75], v[124:127], v[180:183], v[72:75]
  v_mfma_f32_16x16x32_bf16 v[76:79], v[128:131], v[180:183], v[76:79]
  v_mfma_f32_16x16x32_bf16 v[80:83], v[132:135], v[180:183], v[80:83]
  global_load_dwordx4 v[176:179], v12, s[22:23]
  global_load_dwordx4 v[180:183], v12, s[22:23] offset:2048
  s_add_u32 s22, s22, 4096
  s_addc_u32 s23, s23, 0
  s_waitcnt vmcnt(27) lgkmcnt(0)
  s_barrier
  ds_read_b128 v[96:99], v14 offset:20480
  ds_read_b128 v[100:103], v14 offset:21504
  ds_read_b128 v[104:107], v14 offset:22528
  ds_read_b128 v[108:111], v14 offset:23552
  ds_read_b128 v[112:115], v14 offset:24576
  ds_read_b128 v[116:119], v14 offset:25600
  ds_read_b128 v[120:123], v14 offset:26624
  ds_read_b128 v[124:127], v14 offset:27648
  ds_read_b128 v[128:131], v14 offset:28672
  ds_read_b128 v[132:135], v14 offset:29696
  s_add_u32 m0, s25, 0
  s_cmp_ge_u32 s3, 2
  s_cbranch_scc1 L_ow219
  global_load_lds_dwordx4 v14, s[26:27] offset:2048
L_ow219:
  global_load_lds_dwordx4 v14, s[26:27]
  global_load_lds_dwordx4 v14, s[26:27] offset:1024
  s_add_u32 s26, s26, 10240
  s_addc_u32 s27, s27, 0
  v_mfma_f32_16x16x32_bf16 v[64:67], v[136:139], v[184:187], v[64:67]
  v_mfma_f32_16x16x32_bf16 v[68:71], v[140:143], v[184:187], v[68:71]
  v_mfma_f32_16x16x32_bf16 v[72:75], v[144:147], v[184:187], v[72:75]
  v_mfma_f32_16x16x32_bf16 v[76:79], v[148:151], v[184:187], v[76:79]
  v_mfma_f32_16x16x32_bf16 v[80:83], v[152:155], v[184:187], v[80:83]
  v_mfma_f32_16x16x32_bf16 v[64:67], v[156:159], v[188:191], v[64:67]
  v_mfma_f32_16x16x32_bf16 v[68:71], v[160:163], v[188:191], v[68:71]
  v_mfma_f32_16x16x32_bf16 v[72:75], v[164:167], v[188:191], v[72:75]
  v_mfma_f32_16x16x32_bf16 v[76:79], v[168:171], v[188:191], v[76:79]
  v_mfma_f32_16x16x32_bf16 v[80:83], v[172:175], v[188:191], v[80:83]
  global_load_dwordx4 v[184:187], v12, s[22:23]
  global_load_dwordx4 v[188:191], v12, s[22:23] offset:2048
  s_add_u32 s22, s22, 4096
  s_addc_u32 s23, s23, 0
  s_waitcnt vmcnt(27) lgkmcnt(0)
  s_barrier
  ds_read_b128 v[136:139], v14 offset:30720
  ds_read_b128 v[140:143], v14 offset:31744
  ds_read_b128 v[144:147], v14 offset:32768
  ds_read_b128 v[148:151], v14 offset:33792
  ds_read_b128 v[152:155], v14 offset:34816
  ds_read_b128 v[156:159], v14 offset:35840
  ds_read_b128 v[160:163], v14 offset:36864
  ds_read_b128 v[164:167], v14 offset:37888
  ds_read_b128 v[168:171], v14 offset:38912
  ds_read_b128 v[172:175], v14 offset:39936
  s_add_u32 m0, s25, 10240
  s_cmp_ge_u32 s3, 2
  s_cbranch_scc1 L_ow254
  global_load_lds_dwordx4 v14, s[26:27] offset:2048
L_ow254:
  global_load_lds_dwordx4 v14, s[26:27]
  global_load_lds_dwordx4 v14, s[26:27] offset:1024
  s_add_u32 s26, s26, 10240
  s_addc_u32 s27, s27, 0
  v_mfma_f32_16x16x32_bf16 v[64:67], v[96:99], v[192:195], v[64:67]
  v_mfma_f32_16x16x32_bf16 v[68:71], v[100:103], v[192:195], v[68:71]
  v_mfma_f32_16x16x32_bf16 v[72:75], v[104:107], v[192:195], v[72:75]
  v_mfma_f32_16x16x32_bf16 v[76:79], v[108:111], v[192:195], v[76:79]
  v_mfma_f32_16x16x32_bf16 v[80:83], v[112:115], v[192:195], v[80:83]
  v_mfma_f32_16x16x32_bf16 v[64:67], v[116:119], v[196:199], v[64:67]
  v_mfma_f32_16x16x32_bf16 v[68:71], v[120:123], v[196:199], v[68:71]
  v_mfma_f32_16x16x32_bf16 v[72:75], v[124:127], v[196:199], v[72:75]
  v_mfma_f32_16x16x32_bf16 v[76:79], v[128:131], v[196:199], v[76:79]
  v_mfma_f32_16x16x32_bf16 v[80:83], v[132:135], v[196:199], v[80:83]
  global_load_dwordx4 v[192:195], v12, s[22:23]
  global_load_dwordx4 v[196:199], v12, s[22:23] offset:2048
  s_add_u32 s22, s22, 4096
  s_addc_u32 s23, s23, 0
  s_waitcnt vmcnt(27) lgkmcnt(0)
  s_barrier
  ds_read_b128 v[96:99], v15 offset:0
  ds_read_b128 v[100:103], v15 offset:1024
  ds_read_b128 v[104:107], v15 offset:2048
  ds_read_b128 v[108:111], v15 offset:3072
  ds_read_b128 v[112:115], v15 offset:4096
  ds_read_b128 v[116:119], v15 offset:5120
  ds_read_b128 v[120:123], v15 offset:6144
  ds_read_b128 v[124:127], v15 offset:7168
  ds_read_b128 v[128:131], v15 offset:8192
  ds_read_b128 v[132:135], v15 offset:9216
  s_add_u32 m0, s25, 20480
  s_cmp_ge_u32 s3, 2
  s_cbranch_scc1 L_ow289
  global_load_lds_dwordx4 v14, s[26:27] offset:2048
L_ow289:
  global_load_lds_dwordx4 v14, s[26:27]
  global_load_lds_dwordx4 v14, s[26:27] offset:1024
  s_add_u32 s26, s26, 10240
  s_addc_u32 s27, s27, 0
  v_mfma_f32_16x16x32_bf16 v[64:67], v[136:139], v[200:203], v[64:67]
  v_mfma_f32_16x16x32_bf16 v[68:71], v[140:143], v[200:203], v[68:71]
  v_mfma_f32_16x16x32_bf16 v[72:75], v[144:147], v[200:203], v[72:75]
  v_mfma_f32_16x16x32_bf16 v[76:79], v[148:151], v[200:203], v[76:79]
  v_mfma_f32_16x16x32_bf16 v[80:83], v[152:155], v[200:203], v[80:83]
  v_mfma_f32_16x16x32_bf16 v[64:67], v[156:159], v[204:207], v[64:67]
  v_mfma_f32_16x16x32_bf16 v[68:71], v[160:163], v[204:207], v[68:71]
  v_mfma_f32_16x16x32_bf16 v[72:75], v[164:167], v[204:207], v[72:75]
  v_mfma_f32_16x16x32_bf16 v[76:79], v[168:171], v[204:207], v[76:79]
  v_mfma_f32_16x16x32_bf16 v[80:83], v[172:175], v[204:207], v[80:83]
  global_load_dwordx4 v[200:203], v12, s[22:23]
  global_load_dwordx4 v[204:207], v12, s[22:23] offset:2048
  s_add_u32 s22, s22, 4096
  s_addc_u32 s23, s23, 0
  s_waitcnt vmcnt(27) lgkmcnt(0)
  s_barrier
  ds_read_b128 v[136:139], v15 offset:10240
  ds_read_b128 v[140:143], v15 offset:11264
  ds_read_b128 v[144:147], v15 offset:12288
  ds_read_b128 v[148:151], v15 offset:13312
  ds_read_b128 v[152:155], v15 offset:14336
  ds_read_b128 v[156:159], v15 offset:15360
  ds_read_b128 v[160:163], v15 offset:16384
  ds_read_b128 v[164:167], v15 offset:17408
  ds_read_b128 v[168:171], v15 offset:18432
  ds_read_b128 v[172:175], v15 offset:19456
  s_add_u32 m0, s25, 30720
  s_cmp_ge_u32 s3, 2
  s_cbranch_scc1 L_ow324
  global_load_lds_dwordx4 v14, s[26:27] offset:2048
L_ow324:
  global_load_lds_dwordx4 v14, s[26:27]
  global_load_lds_dwordx4 v14, s[26:27] offset:1024
  s_add_u32 s26, s26, 10240
  s_addc_u32 s27, s27, 0
  v_mfma_f32_16x16x32_bf16 v[64:67], v[96:99], v[208:211], v[64:67]
  v_mfma_f32_16x16x32_bf16 v[68:71], v[100:103], v[208:211], v[68:71]
  v_mfma_f32_16x16x32_bf16 v[72:75], v[104:107], v[208:211], v[72:75]
  v_mfma_f32_16x16x32_bf16 v[76:79], v[108:111], v[208:211], v[76:79]
  v_mfma_f32_16x16x32_bf16 v[80:83], v[112:115], v[208:211], v[80:83]
  v_mfma_f32_16x16x32_bf16 v[64:67], v[116:119], v[212:215], v[64:67]
  v_mfma_f32_16x16x32_bf16 v[68:71], v[120:123], v[212:215], v[68:71]
  v_mfma_f32_16x16x32_bf16 v[72:75], v[124:127], v[212:215], v[72:75]
  v_mfma_f32_16x16x32_bf16 v[76:79], v[128:131], v[212:215], v[76:79]
  v_mfma_f32_16x16x32_bf16 v[80:83], v[132:135], v[212:215], v[80:83]
  global_load_dwordx4 v[208:211], v12, s[22:23]
  global_load_dwordx4 v[212:215], v12, s[22:23] offset:2048
  s_add_u32 s22, s22, 4096
  s_addc_u32 s23, s23, 0
  s_waitcnt vmcnt(18) lgkmcnt(0)
  s_barrier
  ds_read_b128 v[96:99], v15 offset:20480
  ds_read_b128 v[100:103], v15 offset:21504
  ds_read_b128 v[104:107], v15 offset:22528
  ds_read_b128 v[108:111], v15 offset:23552
  ds_read_b128 v[112:115], v15 offset:24576
  ds_read_b128 v[116:119], v15 offset:25600
  ds_read_b128 v[120:123], v15 offset:26624
  ds_read_b128 v[124:127], v15 offset:27648
  ds_read_b128 v[128:131], v15 offset:28672
  ds_read_b128 v[132:135], v15 offset:29696
  s_add_u32 m0, s25, 40960
  s_cmp_ge_u32 s3, 2
  s_cbranch_scc1 L_ow359
  global_load_lds_dwordx4 v14, s[26:27] offset:2048
L_ow359:
  global_load_lds_dwordx4 v14, s[26:27]
  global_load_lds_dwordx4 v14, s[26:27] offset:1024
  s_add_u32 s26, s26, 10240
  s_addc_u32 s27, s27, 0
  v_mfma_f32_16x16x32_bf16 v[64:67], v[136:139], v[216:219], v[64:67]
  v_mfma_f32_16x16x32_bf16 v[68:71], v[140:143], v[216:219], v[68:71]
  v_mfma_f32_16x16x32_bf16 v[72:75], v[144:147], v[216:219], v[72:75]
  v_mfma_f32_16x16x32_bf16 v[76:79], v[148:151], v[216:219], v[76:79]
  v_mfma_f32_16x16x32_bf16 v[80:83], v[152:155], v[216:219], v[80:83]
  v_mfma_f32_16x16x32_bf16 v[64:67], v[156:159], v[220:223], v[64:67]
  v_mfma_f32_16x16x32_bf16 v[68:71], v[160:163], v[220:223], v[68:71]
  v_mfma_f32_16x16x32_bf16 v[72:75], v[164:167], v[220:223], v[72:75]
  v_mfma_f32_16x16x32_bf16 v[76:79], v[168:171], v[220:223], v[76:79]
  v_mfma_f32_16x16x32_bf16 v[80:83], v[172:175], v[220:223], v[80:83]
  global_load_dwordx4 v[216:219], v12, s[22:23]
  global_load_dwordx4 v[220:223], v12, s[22:23] offset:2048
  s_add_u32 s22, s22, 4096
  s_addc_u32 s23, s23, 0
  s_waitcnt vmcnt(18) lgkmcnt(0)
  s_barrier
  ds_read_b128 v[136:139], v14 offset:0
  ds_read_b128 v[140:143], v14 offset:1024
  ds_read_b128 v[144:147], v14 offset:2048
  ds_read_b128 v[148:151], v14 offset:3072
  ds_read_b128 v[152:155], v14 offset:4096
  ds_read_b128 v[156:159], v14 offset:5120
  ds_read_b128 v[160:163], v14 offset:6144
  ds_read_b128 v[164:167], v14 offset:7168
  ds_read_b128 v[168:171], v14 offset:8192
  ds_read_b128 v[172:175], v14 offset:9216
  s_add_u32 m0, s25, 51200
  s_cmp_ge_u32 s3, 2
  s_cbranch_scc1 L_ow394
  global_load_lds_dwordx4 v14, s[26:27] offset:2048
L_ow394:
  global_load_lds_dwordx4 v14, s[26:27]
  global_load_lds_dwordx4 v14, s[26:27] offset:1024
  s_add_u32 s26, s26, 10240
  s_addc_u32 s27, s27, 0
  v_mfma_f32_16x16x32_bf16 v[64:67], v[96:99], v[224:227], v[64:67]
  v_mfma_f32_16x16x32_bf16 v[68:71], v[100:103], v[224:227], v[68:71]
  v_mfma_f32_16x16x32_bf16 v[72:75], v[104:107], v[224:227], v[72:75]
  v_mfma_f32_16x16x32_bf16 v[76:79], v[108:111], v[224:227], v[76:79]
  v_mfma_f32_16x16x32_bf16 v[80:83], v[112:115], v[224:227], v[80:83]
  v_mfma_f32_16x16x32_bf16 v[64:67], v[116:119], v[228:231], v[64:67]
  v_mfma_f32_16x16x32_bf16 v[68:71], v[120:123], v[228:231], v[68:71]
  v_mfma_f32_16x16x32_bf16 v[72:75], v[124:127], v[228:231], v[72:75]
  v_mfma_f32_16x16x32_bf16 v[76:79], v[128:131], v[228:231], v[76:79]
  v_mfma_f32_16x16x32_bf16 v[80:83], v[132:135], v[228:231], v[80:83]
  global_load_dwordx4 v[224:227], v12, s[22:23]
  global_load_dwordx4 v[228:231], v12, s[22:23] offset:2048
  s_add_u32 s22, s22, 4096
  s_addc_u32 s23, s23, 0
  s_waitcnt vmcnt(18) lgkmcnt(0)
  s_barrier
  ds_read_b128 v[96:99], v14 offset:10240
  ds_read_b128 v[100:103], v14 offset:11264
  ds_read_b128 v[104:107], v14 offset:12288
  ds_read_b128 v[108:111], v14 offset:13312
  ds_read_b128 v[112:115], v14 offset:14336
  ds_read_b128 v[116:119], v14 offset:15360
  ds_read_b128 v[120:123], v14 offset:16384
  ds_read_b128 v[124:127], v14 offset:17408
  ds_read_b128 v[128:131], v14 offset:18432
  ds_read_b128 v[132:135], v14 offset:19456
  s_add_u32 m0, s25, 61440
  s_cmp_ge_u32 s3, 2
  s_cbranch_scc1 L_ow429
  global_load_lds_dwordx4 v14, s[26:27] offset:2048
L_ow429:
  global_load_lds_dwordx4 v14, s[26:27]
  global_load_lds_dwordx4 v14, s[26:27] offset:1024
  s_add_u32 s26, s26, 10240
  s_addc_u32 s27, s27, 0
  v_mfma_f32_16x16x32_bf16 v[64:67], v[136:139], v[232:235], v[64:67]
  v_mfma_f32_16x16x32_bf16 v[68:71], v[140:143], v[232:235], v[68:71]
  v_mfma_f32_16x16x32_bf16 v[72:75], v[144:147], v[232:235], v[72:75]
  v_mfma_f32_16x16x32_bf16 v[76:79], v[148:151], v[232:235], v[76:79]
  v_mfma_f32_16x16x32_bf16 v[80:83], v[152:155], v[232:235], v[80:83]
  v_mfma_f32_16x16x32_bf16 v[64:67], v[156:159], v[236:239], v[64:67]
  v_mfma_f32_16x16x32_bf16 v[68:71], v[160:163], v[236:239], v[68:71]
  v_mfma_f32_16x16x32_bf16 v[72:75], v[164:167], v[236:239], v[72:75]
  v_mfma_f32_16x16x32_bf16 v[76:79], v[168:171], v[236:239], v[76:79]
  v_mfma_f32_16x16x32_bf16 v[80:83], v[172:175], v[236:239], v[80:83]
  global_load_dwordx4 v[232:235], v12, s[22:23]
  global_load_dwordx4 v[236:239], v12, s[22:23] offset:2048
  s_add_u32 s22, s22, 4096
  s_addc_u32 s23, s23, 0
  s_waitcnt vmcnt(18) lgkmcnt(0)
  s_barrier
  ds_read_b128 v[136:139], v14 offset:20480
  ds_read_b128 v[140:143], v14 offset:21504
  ds_read_b128 v[144:147], v14 offset:22528
  ds_read_b128 v[148:151], v14 offset:23552
  ds_read_b128 v[152:155], v14 offset:24576
  ds_read_b128 v[156:159], v14 offset:25600
  ds_read_b128 v[160:163], v14 offset:26624
  ds_read_b128 v[164:167], v14 offset:27648
  ds_read_b128 v[168:171], v14 offset:28672
  ds_read_b128 v[172:175], v14 offset:29696
  s_add_u32 m0, s25, 0
  s_cmp_ge_u32 s3, 2
  s_cbranch_scc1 L_ow464
  global_load_lds_dwordx4 v14, s[26:27] offset:2048
L_ow464:
  global_load_lds_dwordx4 v14, s[26:27]
  global_load_lds_dwordx4 v14, s[26:27] offset:1024
  s_add_u32 s26, s26, 10240
  s_addc_u32 s27, s27, 0
  v_mfma_f32_16x16x32_bf16 v[64:67], v[96:99], v[176:179], v[64:67]
  v_mfma_f32_16x16x32_bf16 v[68:71], v[100:103], v[176:179], v[68:71]
  v_mfma_f32_16x16x32_bf16 v[72:75], v[104:107], v[176:179], v[72:75]
  v_mfma_f32_16x16x32_bf16 v[76:79], v[108:111], v[176:179], v[76:79]
  v_mfma_f32_16x16x32_bf16 v[80:83], v[112:115], v[176:179], v[80:83]
  v_mfma_f32_16x16x32_bf16 v[64:67], v[116:119], v[180:183], v[64:67]
  v_mfma_f32_16x16x32_bf16 v[68:71], v[120:123], v[180:183], v[68:71]
  v_mfma_f32_16x16x32_bf16 v[72:75], v[124:127], v[180:183], v[72:75]
  v_mfma_f32_16x16x32_bf16 v[76:79], v[128:131], v[180:183], v[76:79]
  v_mfma_f32_16x16x32_bf16 v[80:83], v[132:135], v[180:183], v[80:83]
  global_load_dwordx4 v[176:179], v12, s[22:23]
  global_load_dwordx4 v[180:183], v12, s[22:23] offset:2048
  s_add_u32 s22, s22, 4096
  s_addc_u32 s23, s23, 0
  s_waitcnt vmcnt(18) lgkmcnt(0)
  s_barrier
  ds_read_b128 v[96:99], v14 offset:30720
  ds_read_b128 v[100:103], v14 offset:31744
  ds_read_b128 v[104:107], v14 offset:32768
  ds_read_b128 v[108:111], v14 offset:33792
  ds_read_b128 v[112:115], v14 offset:34816
  ds_read_b128 v[116:119], v14 offset:35840
  ds_read_b128 v[120:123], v14 offset:36864
  ds_read_b128 v[124:127], v14 offset:37888
  ds_read_b128 v[128:131], v14 offset:38912
  ds_read_b128 v[132:135], v14 offset:39936
  s_add_u32 m0, s25, 10240
  s_cmp_ge_u32 s3, 2
  s_cbranch_scc1 L_ow499
  global_load_lds_dwordx4 v14, s[26:27] offset:2048
L_ow499:
  global_load_lds_dwordx4 v14, s[26:27]
  global_load_lds_dwordx4 v14, s[26:27] offset:1024
  s_add_u32 s26, s26, 10240
  s_addc_u32 s27, s27, 0
  v_mfma_f32_16x16x32_bf16 v[64:67], v[136:139], v[184:187], v[64:67]
  v_mfma_f32_16x16x32_bf16 v[68:71], v[140:143], v[184:187], v[68:71]
  v_mfma_f32_16x16x32_bf16 v[72:75], v[144:147], v[184:187], v[72:75]
  v_mfma_f32_16x16x32_bf16 v[76:79], v[148:151], v[184:187], v[76:79]
  v_mfma_f32_16x16x32_bf16 v[80:83], v[152:155], v[184:187], v[80:83]
  v_mfma_f32_16x16x32_bf16 v[64:67], v[156:159], v[188:191], v[64:67]
  v_mfma_f32_16x16x32_bf16 v[68:71], v[160:163], v[188:191], v[68:71]
  v_mfma_f32_16x16x32_bf16 v[72:75], v[164:167], v[188:191], v[72:75]
  v_mfma_f32_16x16x32_bf16 v[76:79], v[168:171], v[188:191], v[76:79]
  v_mfma_f32_16x16x32_bf16 v[80:83], v[172:175], v[188:191], v[80:83]
  global_load_dwordx4 v[184:187], v12, s[22:23]
  global_load_dwordx4 v[188:191], v12, s[22:23] offset:2048
  s_add_u32 s22, s22, 4096
  s_addc_u32 s23, s23, 0
  s_waitcnt vmcnt(18) lgkmcnt(0)
  s_barrier
  ds_read_b128 v[136:139], v15 offset:0
  ds_read_b128 v[140:143], v15 offset:1024
  ds_read_b128 v[144:147], v15 offset:2048
  ds_read_b128 v[148:151], v15 offset:3072
  ds_read_b128 v[152:155], v15 offset:4096
  ds_read_b128 v[156:159], v15 offset:5120
  ds_read_b128 v[160:163], v15 offset:6144
  ds_read_b128 v[164:167], v15 offset:7168
  ds_read_b128 v[168:171], v15 offset:8192
  ds_read_b128 v[172:175], v15 offset:9216
  s_add_u32 m0, s25, 20480
  s_cmp_ge_u32 s3, 2
  s_cbranch_scc1 L_ow534
  global_load_lds_dwordx4 v14, s[26:27] offset:2048
L_ow534:
  global_load_lds_dwordx4 v14, s[26:27]
  global_load_lds_dwordx4 v14, s[26:27] offset:1024
  s_add_u32 s26, s26, 10240
  s_addc_u32 s27, s27, 0
  v_mfma_f32_16x16x32_bf16 v[64:67], v[96:99], v[192:195], v[64:67]
  v_mfma_f32_16x16x32_bf16 v[68:71], v[100:103], v[192:195], v[68:71]
  v_mfma_f32_16x16x32_bf16 v[72:75], v[104:107], v[192:195], v[72:75]
  v_mfma_f32_16x16x32_bf16 v[76:79], v[108:111], v[192:195], v[76:79]
  v_mfma_f32_16x16x32_bf16 v[80:83], v[112:115], v[192:195], v[80:83]
  v_mfma_f32_16x16x32_bf16 v[64:67], v[116:119], v[196:199], v[64:67]
  v_mfma_f32_16x16x32_bf16 v[68:71], v[120:123], v[196:199], v[68:71]
  v_mfma_f32_16x16x32_bf16 v[72:75], v[124:127], v[196:199], v[72:75]
  v_mfma_f32_16x16x32_bf16 v[76:79], v[128:131], v[196:199], v[76:79]
  v_mfma_f32_16x16x32_bf16 v[80:83], v[132:135], v[196:199], v[80:83]
  global_load_dwordx4 v[192:195], v12, s[22:23]
  global_load_dwordx4 v[196:199], v12, s[22:23] offset:2048
  s_add_u32 s22, s22, 4096
  s_addc_u32 s23, s23, 0
  s_waitcnt vmcnt(18) lgkmcnt(0)
  s_barrier
  ds_read_b128 v[96:99], v15 offset:10240
  ds_read_b128 v[100:103], v15 offset:11264
  ds_read_b128 v[104:107], v15 offset:12288
  ds_read_b128 v[108:111], v15 offset:13312
  ds_read_b128 v[112:115], v15 offset:14336
  ds_read_b128 v[116:119], v15 offset:15360
  ds_read_b128 v[120:123], v15 offset:16384
  ds_read_b128 v[124:127], v15 offset:17408
  ds_read_b128 v[128:131], v15 offset:18432
  ds_read_b128 v[132:135], v15 offset:19456
  s_add_u32 m0, s25, 30720
  s_cmp_ge_u32 s3, 2
  s_cbranch_scc1 L_ow569
  global_load_lds_dwordx4 v14, s[26:27] offset:2048
L_ow569:
  global_load_lds_dwordx4 v14, s[26:27]
  global_load_lds_dwordx4 v14, s[26:27] offset:1024
  s_add_u32 s26, s26, 10240
  s_addc_u32 s27, s27, 0
  v_mfma_f32_16x16x32_bf16 v[64:67], v[136:139], v[200:203], v[64:67]
  v_mfma_f32_16x16x32_bf16 v[68:71], v[140:143], v[200:203], v[68:71]
  v_mfma_f32_16x16x32_bf16 v[72:75], v[144:147], v[200:203], v[72:75]
  v_mfma_f32_16x16x32_bf16 v[76:79], v[148:151], v[200:203], v[76:79]
  v_mfma_f32_16x16x32_bf16 v[80:83], v[152:155], v[200:203], v[80:83]
  v_mfma_f32_16x16x32_bf16 v[64:67], v[156:159], v[204:207], v[64:67]
  v_mfma_f32_16x16x32_bf16 v[68:71], v[160:163], v[204:207], v[68:71]
  v_mfma_f32_16x16x32_bf16 v[72:75], v[164:167], v[204:207], v[72:75]
  v_mfma_f32_16x16x32_bf16 v[76:79], v[168:171], v[204:207], v[76:79]
  v_mfma_f32_16x16x32_bf16 v[80:83], v[172:175], v[204:207], v[80:83]
  global_load_dwordx4 v[200:203], v12, s[22:23]
  global_load_dwordx4 v[204:207], v12, s[22:23] offset:2048
  s_add_u32 s22, s22, 4096
  s_addc_u32 s23, s23, 0
  s_waitcnt vmcnt(18) lgkmcnt(0)
  s_barrier
  ds_read_b128 v[136:139], v15 offset:20480
  ds_read_b128 v[140:143], v15 offset:21504
  ds_read_b128 v[144:147], v15 offset:22528
  ds_read_b128 v[148:151], v15 offset:23552
  ds_read_b128 v[152:155], v15 offset:24576
  ds_read_b128 v[156:159], v15 offset:25600
  ds_read_b128 v[160:163], v15 offset:26624
  ds_read_b128 v[164:167], v15 offset:27648
  ds_read_b128 v[168:171], v15 offset:28672
  ds_read_b128 v[172:175], v15 offset:29696
  s_add_u32 m0, s25, 40960
  s_cmp_ge_u32 s3, 2
  s_cbranch_scc1 L_ow604
  global_load_lds_dwordx4 v14, s[26:27] offset:2048
L_ow604:
  global_load_lds_dwordx4 v14, s[26:27]
  global_load_lds_dwordx4 v14, s[26:27] offset:1024
  s_add_u32 s26, s26, 10240
  s_addc_u32 s27, s27, 0
  v_mfma_f32_16x16x32_bf16 v[64:67], v[96:99], v[208:211], v[64:67]
  v_mfma_f32_16x16x32_bf16 v[68:71], v[100:103], v[208:211], v[68:71]
  v_mfma_f32_16x16x32_bf16 v[72:75], v[104:107], v[208:211], v[72:75]
  v_mfma_f32_16x16x32_bf16 v[76:79], v[108:111], v[208:211], v[76:79]
  v_mfma_f32_16x16x32_bf16 v[80:83], v[112:115], v[208:211], v[80:83]
  v_mfma_f32_16x16x32_bf16 v[64:67], v[116:119], v[212:215], v[64:67]
  v_mfma_f32_16x16x32_bf16 v[68:71], v[120:123], v[212:215], v[68:71]
  v_mfma_f32_16x16x32_bf16 v[72:75], v[124:127], v[212:215], v[72:75]
  v_mfma_f32_16x16x32_bf16 v[76:79], v[128:131], v[212:215], v[76:79]
  v_mfma_f32_16x16x32_bf16 v[80:83], v[132:135], v[212:215], v[80:83]
  global_load_dwordx4 v[208:211], v12, s[22:23]
  global_load_dwordx4 v[212:215], v12, s[22:23] offset:2048
  s_add_u32 s22, s22, 4096
  s_addc_u32 s23, s23, 0
  s_waitcnt vmcnt(18) lgkmcnt(0)
  s_barrier
  ds_read_b128 v[96:99], v14 offset:0
  ds_read_b128 v[100:103], v14 offset:1024
  ds_read_b128 v[104:107], v14 offset:2048
  ds_read_b128 v[108:111], v14 offset:3072
  ds_read_b128 v[112:115], v14 offset:4096
  ds_read_b128 v[116:119], v14 offset:5120
  ds_read_b128 v[120:123], v14 offset:6144
  ds_read_b128 v[124:127], v14 offset:7168
  ds_read_b128 v[128:131], v14 offset:8192
  ds_read_b128 v[132:135], v14 offset:9216
  s_add_u32 m0, s25, 51200
  s_cmp_ge_u32 s3, 2
  s_cbranch_scc1 L_ow639
  global_load_lds_dwordx4 v14, s[26:27] offset:2048
L_ow639:
  global_load_lds_dwordx4 v14, s[26:27]
  global_load_lds_dwordx4 v14, s[26:27] offset:1024
  s_add_u32 s26, s26, 10240
  s_addc_u32 s27, s27, 0
  v_mfma_f32_16x16x32_bf16 v[64:67], v[136:139], v[216:219], v[64:67]
  v_mfma_f32_16x16x32_bf16 v[68:71], v[140:143], v[216:219], v[68:71]
  v_mfma_f32_16x16x32_bf16 v[72:75], v[144:147], v[216:219], v[72:75]
  v_mfma_f32_16x16x32_bf16 v[76:79], v[148:151], v[216:219], v[76:79]
  v_mfma_f32_16x16x32_bf16 v[80:83], v[152:155], v[216:219], v[80:83]
  v_mfma_f32_16x16x32_bf16 v[64:67], v[156:159], v[220:223], v[64:67]
  v_mfma_f32_16x16x32_bf16 v[68:71], v[160:163], v[220:223], v[68:71]
  v_mfma_f32_16x16x32_bf16 v[72:75], v[164:167], v[220:223], v[72:75]
  v_mfma_f32_16x16x32_bf16 v[76:79], v[168:171], v[220:223], v[76:79]
  v_mfma_f32_16x16x32_bf16 v[80:83], v[172:175], v[220:223], v[80:83]
  global_load_dwordx4 v[216:219], v12, s[22:23]
  global_load_dwordx4 v[220:223], v12, s[22:23] offset:2048
  s_add_u32 s22, s22, 4096
  s_addc_u32 s23, s23, 0
  s_waitcnt vmcnt(18) lgkmcnt(0)
  s_barrier
  ds_read_b128 v[136:139], v14 offset:10240
  ds_read_b128 v[140:143], v14 offset:11264
  ds_read_b128 v[144:147], v14 offset:12288
  ds_read_b128 v[148:151], v14 offset:13312
  ds_read_b128 v[152:155], v14 offset:14336
  ds_read_b128 v[156:159], v14 offset:15360
  ds_read_b128 v[160:163], v14 offset:16384
  ds_read_b128 v[164:167], v14 offset:17408
  ds_read_b128 v[168:171], v14 offset:18432
  ds_read_b128 v[172:175], v14 offset:19456
  s_add_u32 m0, s25, 61440
  s_cmp_ge_u32 s3, 2
  s_cbranch_scc1 L_ow674
  global_load_lds_dwordx4 v14, s[26:27] offset:2048
L_ow674:
  global_load_lds_dwordx4 v14, s[26:27]
  global_load_lds_dwordx4 v14, s[26:27] offset:1024
  s_add_u32 s26, s26, 10240
  s_addc_u32 s27, s27, 0
  v_mfma_f32_16x16x32_bf16 v[64:67], v[96:99], v[224:227], v[64:67]
  v_mfma_f32_16x16x32_bf16 v[68:71], v[100:103], v[224:227], v[68:71]
  v_mfma_f32_16x16x32_bf16 v[72:75], v[104:107], v[224:227], v[72:75]
  v_mfma_f32_16x16x32_bf16 v[76:79], v[108:111], v[224:227], v[76:79]
  v_mfma_f32_16x16x32_bf16 v[80:83], v[112:115], v[224:227], v[80:83]
  v_mfma_f32_16x16x32_bf16 v[64:67], v[116:119], v[228:231], v[64:67]
  v_mfma_f32_16x16x32_bf16 v[68:71], v[120:123], v[228:231], v[68:71]
  v_mfma_f32_16x16x32_bf16 v[72:75], v[124:127], v[228:231], v[72:75]
  v_mfma_f32_16x16x32_bf16 v[76:79], v[128:131], v[228:231], v[76:79]
  v_mfma_f32_16x16x32_bf16 v[80:83], v[132:135], v[228:231], v[80:83]
  global_load_dwordx4 v[224:227], v12, s[22:23]
  global_load_dwordx4 v[228:231], v12, s[22:23] offset:2048
  s_add_u32 s22, s22, 4096
  s_addc_u32 s23, s23, 0
  s_waitcnt vmcnt(18) lgkmcnt(0)
  s_barrier
  ds_read_b128 v[96:99], v14 offset:20480
  ds_read_b128 v[100:103], v14 offset:21504
  ds_read_b128 v[104:107], v14 offset:22528
  ds_read_b128 v[108:111], v14 offset:23552
  ds_read_b128 v[112:115], v14 offset:24576
  ds_read_b128 v[116:119], v14 offset:25600
  ds_read_b128 v[120:123], v14 offset:26624
  ds_read_b128 v[124:127], v14 offset:27648
  ds_read_b128 v[128:131], v14 offset:28672
  ds_read_b128 v[132:135], v14 offset:29696
  s_add_u32 m0, s25, 0
  s_cmp_ge_u32 s3, 2
  s_cbranch_scc1 L_ow709
  global_load_lds_dwordx4 v14, s[26:27] offset:2048
L_ow709:
  global_load_lds_dwordx4 v14, s[26:27]
  global_load_lds_dwordx4 v14, s[26:27] offset:1024
  s_add_u32 s26, s26, 10240
  s_addc_u32 s27, s27, 0
  v_mfma_f32_16x16x32_bf16 v[64:67], v[136:139], v[232:235], v[64:67]
  v_mfma_f32_16x16x32_bf16 v[68:71], v[140:143], v[232:235], v[68:71]
  v_mfma_f32_16x16x32_bf16 v[72:75], v[144:147], v[232:235], v[72:75]
  v_mfma_f32_16x16x32_bf16 v[76:79], v[148:151], v[232:235], v[76:79]
  v_mfma_f32_16x16x32_bf16 v[80:83], v[152:155], v[232:235], v[80:83]
  v_mfma_f32_16x16x32_bf16 v[64:67], v[156:159], v[236:239], v[64:67]
  v_mfma_f32_16x16x32_bf16 v[68:71], v[160:163], v[236:239], v[68:71]
  v_mfma_f32_16x16x32_bf16 v[72:75], v[164:167], v[236:239], v[72:75]
  v_mfma_f32_16x16x32_bf16 v[76:79], v[168:171], v[236:239], v[76:79]
  v_mfma_f32_16x16x32_bf16 v[80:83], v[172:175], v[236:239], v[80:83]
  global_load_dwordx4 v[232:235], v12, s[22:23]
  global_load_dwordx4 v[236:239], v12, s[22:23] offset:2048
  s_add_u32 s22, s22, 4096
  s_addc_u32 s23, s23, 0
  s_waitcnt vmcnt(18) lgkmcnt(0)
  s_barrier
  ds_read_b128 v[136:139], v14 offset:30720
  ds_read_b128 v[140:143], v14 offset:31744
  ds_read_b128 v[144:147], v14 offset:32768
  ds_read_b128 v[148:151], v14 offset:33792
  ds_read_b128 v[152:155], v14 offset:34816
  ds_read_b128 v[156:159], v14 offset:35840
  ds_read_b128 v[160:163], v14 offset:36864
  ds_read_b128 v[164:167], v14 offset:37888
  ds_read_b128 v[168:171], v14 offset:38912
  ds_read_b128 v[172:175], v14 offset:39936
  s_add_u32 m0, s25, 10240
  s_cmp_ge_u32 s3, 2
  s_cbranch_scc1 L_ow744
  global_load_lds_dwordx4 v14, s[26:27] offset:2048
L_ow744:
  global_load_lds_dwordx4 v14, s[26:27]
  global_load_lds_dwordx4 v14, s[26:27] offset:1024
  s_add_u32 s26, s26, 10240
  s_addc_u32 s27, s27, 0
  v_mfma_f32_16x16x32_bf16 v[64:67], v[96:99], v[176:179], v[64:67]
  v_mfma_f32_16x16x32_bf16 v[68:71], v[100:103], v[176:179], v[68:71]
  v_mfma_f32_16x16x32_bf16 v[72:75], v[104:107], v[176:179], v[72:75]
  v_mfma_f32_16x16x32_bf16 v[76:79], v[108:111], v[176:179], v[76:79]
  v_mfma_f32_16x16x32_bf16 v[80:83], v[112:115], v[176:179], v[80:83]
  v_mfma_f32_16x16x32_bf16 v[64:67], v[116:119], v[180:183], v[64:67]
  v_mfma_f32_16x16x32_bf16 v[68:71], v[120:123], v[180:183], v[68:71]
  v_mfma_f32_16x16x32_bf16 v[72:75], v[124:127], v[180:183], v[72:75]
  v_mfma_f32_16x16x32_bf16 v[76:79], v[128:131], v[180:183], v[76:79]
  v_mfma_f32_16x16x32_bf16 v[80:83], v[132:135], v[180:183], v[80:83]
  global_load_dwordx4 v[176:179], v12, s[22:23]
  global_load_dwordx4 v[180:183], v12, s[22:23] offset:2048
  s_add_u32 s22, s22, 4096
  s_addc_u32 s23, s23, 0
  s_waitcnt vmcnt(18) lgkmcnt(0)
  s_barrier
  ds_read_b128 v[96:99], v15 offset:0
  ds_read_b128 v[100:103], v15 offset:1024
  ds_read_b128 v[104:107], v15 offset:2048
  ds_read_b128 v[108:111], v15 offset:3072
  ds_read_b128 v[112:115], v15 offset:4096
  ds_read_b128 v[116:119], v15 offset:5120
  ds_read_b128 v[120:123], v15 offset:6144
  ds_read_b128 v[124:127], v15 offset:7168
  ds_read_b128 v[128:131], v15 offset:8192
  ds_read_b128 v[132:135], v15 offset:9216
  s_add_u32 m0, s25, 20480
  s_cmp_ge_u32 s3, 2
  s_cbranch_scc1 L_ow779
  global_load_lds_dwordx4 v14, s[26:27] offset:2048
L_ow779:
  global_load_lds_dwordx4 v14, s[26:27]
  global_load_lds_dwordx4 v14, s[26:27] offset:1024
  s_add_u32 s26, s26, 10240
  s_addc_u32 s27, s27, 0
  v_mfma_f32_16x16x32_bf16 v[64:67], v[136:139], v[184:187], v[64:67]
  v_mfma_f32_16x16x32_bf16 v[68:71], v[140:143], v[184:187], v[68:71]
  v_mfma_f32_16x16x32_bf16 v[72:75], v[144:147], v[184:187], v[72:75]
  v_mfma_f32_16x16x32_bf16 v[76:79], v[148:151], v[184:187], v[76:79]
  v_mfma_f32_16x16x32_bf16 v[80:83], v[152:155], v[184:187], v[80:83]
  v_mfma_f32_16x16x32_bf16 v[64:67], v[156:159], v[188:191], v[64:67]
  v_mfma_f32_16x16x32_bf16 v[68:71], v[160:163], v[188:191], v[68:71]
  v_mfma_f32_16x16x32_bf16 v[72:75], v[164:167], v[188:191], v[72:75]
  v_mfma_f32_16x16x32_bf16 v[76:79], v[168:171], v[188:191], v[76:79]
  v_mfma_f32_16x16x32_bf16 v[80:83], v[172:175], v[188:191], v[80:83]
  global_load_dwordx4 v[184:187], v12, s[22:23]
  global_load_dwordx4 v[188:191], v12, s[22:23] offset:2048
  s_add_u32 s22, s22, 4096
  s_addc_u32 s23, s23, 0
  s_waitcnt vmcnt(18) lgkmcnt(0)
  s_barrier
  ds_read_b128 v[136:139], v15 offset:10240
  ds_read_b128 v[140:143], v15 offset:11264
  ds_read_b128 v[144:147], v15 offset:12288
  ds_read_b128 v[148:151], v15 offset:13312
  ds_read_b128 v[152:155], v15 offset:14336
  ds_read_b128 v[156:159], v15 offset:15360
  ds_read_b128 v[160:163], v15 offset:16384
  ds_read_b128 v[164:167], v15 offset:17408
  ds_read_b128 v[168:171], v15 offset:18432
  ds_read_b128 v[172:175], v15 offset:19456
  s_add_u32 m0, s25, 30720
  s_cmp_ge_u32 s3, 2
  s_cbranch_scc1 L_ow814
  global_load_lds_dwordx4 v14, s[26:27] offset:2048
L_ow814:
  global_load_lds_dwordx4 v14, s[26:27]
  global_load_lds_dwordx4 v14, s[26:27] offset:1024
  s_add_u32 s26, s26, 10240
  s_addc_u32 s27, s27, 0
  v_mfma_f32_16x16x32_bf16 v[64:67], v[96:99], v[192:195], v[64:67]
  v_mfma_f32_16x16x32_bf16 v[68:71], v[100:103], v[192:195], v[68:71]
  v_mfma_f32_16x16x32_bf16 v[72:75], v[104:107], v[192:195], v[72:75]
  v_mfma_f32_16x16x32_bf16 v[76:79], v[108:111], v[192:195], v[76:79]
  v_mfma_f32_16x16x32_bf16 v[80:83], v[112:115], v[192:195], v[80:83]
  v_mfma_f32_16x16x32_bf16 v[64:67], v[116:119], v[196:199], v[64:67]
  v_mfma_f32_16x16x32_bf16 v[68:71], v[120:123], v[196:199], v[68:71]
  v_mfma_f32_16x16x32_bf16 v[72:75], v[124:127], v[196:199], v[72:75]
  v_mfma_f32_16x16x32_bf16 v[76:79], v[128:131], v[196:199], v[76:79]
  v_mfma_f32_16x16x32_bf16 v[80:83], v[132:135], v[196:199], v[80:83]
  global_load_dwordx4 v[192:195], v12, s[22:23]
  global_load_dwordx4 v[196:199], v12, s[22:23] offset:2048
  s_add_u32 s22, s22, 4096
  s_addc_u32 s23, s23, 0
  s_waitcnt vmcnt(18) lgkmcnt(0)
  s_barrier
  ds_read_b128 v[96:99], v15 offset:20480
  ds_read_b128 v[100:103], v15 offset:21504
  ds_read_b128 v[104:107], v15 offset:22528
  ds_read_b128 v[108:111], v15 offset:23552
  ds_read_b128 v[112:115], v15 offset:24576
  ds_read_b128 v[116:119], v15 offset:25600
  ds_read_b128 v[120:123], v15 offset:26624
  ds_read_b128 v[124:127], v15 offset:27648
  ds_read_b128 v[128:131], v15 offset:28672
  ds_read_b128 v[132:135], v15 offset:29696
  s_add_u32 m0, s25, 40960
  s_cmp_ge_u32 s3, 2
  s_cbranch_scc1 L_ow849
  global_load_lds_dwordx4 v14, s[26:27] offset:2048
L_ow849:
  global_load_lds_dwordx4 v14, s[26:27]
  global_load_lds_dwordx4 v14, s[26:27] offset:1024
  s_add_u32 s26, s26, 10240
  s_addc_u32 s27, s27, 0
  v_mfma_f32_16x16x32_bf16 v[64:67], v[136:139], v[200:203], v[64:67]
  v_mfma_f32_16x16x32_bf16 v[68:71], v[140:143], v[200:203], v[68:71]
  v_mfma_f32_16x16x32_bf16 v[72:75], v[144:147], v[200:203], v[72:75]
  v_mfma_f32_16x16x32_bf16 v[76:79], v[148:151], v[200:203], v[76:79]
  v_mfma_f32_16x16x32_bf16 v[80:83], v[152:155], v[200:203], v[80:83]
  v_mfma_f32_16x16x32_bf16 v[64:67], v[156:159], v[204:207], v[64:67]
  v_mfma_f32_16x16x32_bf16 v[68:71], v[160:163], v[204:207], v[68:71]
  v_mfma_f32_16x16x32_bf16 v[72:75], v[164:167], v[204:207], v[72:75]
  v_mfma_f32_16x16x32_bf16 v[76:79], v[168:171], v[204:207], v[76:79]
  v_mfma_f32_16x16x32_bf16 v[80:83], v[172:175], v[204:207], v[80:83]
  s_mov_b32 s22, s34
  s_mov_b32 s23, s35
  global_load_dwordx4 v[200:203], v12, s[22:23]
  global_load_dwordx4 v[204:207], v12, s[22:23] offset:2048
  s_add_u32 s22, s22, 4096
  s_addc_u32 s23, s23, 0
  s_waitcnt vmcnt(18) lgkmcnt(0)
  s_barrier
  ds_read_b128 v[136:139], v14 offset:0
  ds_read_b128 v[140:143], v14 offset:1024
  ds_read_b128 v[144:147], v14 offset:2048
  ds_read_b128 v[148:151], v14 offset:3072
  ds_read_b128 v[152:155], v14 offset:4096
  ds_read_b128 v[156:159], v14 offset:5120
  ds_read_b128 v[160:163], v14 offset:6144
  ds_read_b128 v[164:167], v14 offset:7168
  ds_read_b128 v[168:171], v14 offset:8192
  ds_read_b128 v[172:175], v14 offset:9216
  s_add_u32 m0, s25, 51200
  s_cmp_ge_u32 s3, 2
  s_cbranch_scc1 L_ow886
  global_load_lds_dwordx4 v14, s[26:27] offset:2048
L_ow886:
  global_load_lds_dwordx4 v14, s[26:27]
  global_load_lds_dwordx4 v14, s[26:27] offset:1024
  s_add_u32 s26, s26, 10240
  s_addc_u32 s27, s27, 0
  v_mfma_f32_16x16x32_bf16 v[64:67], v[96:99], v[208:211], v[64:67]
  v_mfma_f32_16x16x32_bf16 v[68:71], v[100:103], v[208:211], v[68:71]
  v_mfma_f32_16x16x32_bf16 v[72:75], v[104:107], v[208:211], v[72:75]
  v_mfma_f32_16x16x32_bf16 v[76:79], v[108:111], v[208:211], v[76:79]
  v_mfma_f32_16x16x32_bf16 v[80:83], v[112:115], v[208:211], v[80:83]
  v_mfma_f32_16x16x32_bf16 v[64:67], v[116:119], v[212:215], v[64:67]
  v_mfma_f32_16x16x32_bf16 v[68:71], v[120:123], v[212:215], v[68:71]
  v_mfma_f32_16x16x32_bf16 v[72:75], v[124:127], v[212:215], v[72:75]
  v_mfma_f32_16x16x32_bf16 v[76:79], v[128:131], v[212:215], v[76:79]
  v_mfma_f32_16x16x32_bf16 v[80:83], v[132:135], v[212:215], v[80:83]
  global_load_dwordx4 v[208:211], v12, s[22:23]
  global_load_dwordx4 v[212:215], v12, s[22:23] offset:2048
  s_add_u32 s22, s22, 4096
  s_addc_u32 s23, s23, 0
  s_waitcnt vmcnt(18) lgkmcnt(0)
  s_barrier
  ds_read_b128 v[96:99], v14 offset:10240
  ds_read_b128 v[100:103], v14 offset:11264
  ds_read_b128 v[104:107], v14 offset:12288
  ds_read_b128 v[108:111], v14 offset:13312
  ds_read_b128 v[112:115], v14 offset:14336
  ds_read_b128 v[116:119], v14 offset:15360
  ds_read_b128 v[120:123], v14 offset:16384
  ds_read_b128 v[124:127], v14 offset:17408
  ds_read_b128 v[128:131], v14 offset:18432
  ds_read_b128 v[132:135], v14 offset:19456
  s_add_u32 m0, s25, 61440
  s_cmp_ge_u32 s3, 2
  s_cbranch_scc1 L_ow921
  global_load_lds_dwordx4 v14, s[26:27] offset:2048
L_ow921:
  global_load_lds_dwordx4 v14, s[26:27]
  global_load_lds_dwordx4 v14, s[26:27] offset:1024
  s_add_u32 s26, s26, 10240
  s_addc_u32 s27, s27, 0
  v_mfma_f32_16x16x32_bf16 v[64:67], v[136:139], v[216:219], v[64:67]
  v_mfma_f32_16x16x32_bf16 v[68:71], v[140:143], v[216:219], v[68:71]
  v_mfma_f32_16x16x32_bf16 v[72:75], v[144:147], v[216:219], v[72:75]
  v_mfma_f32_16x16x32_bf16 v[76:79], v[148:151], v[216:219], v[76:79]
  v_mfma_f32_16x16x32_bf16 v[80:83], v[152:155], v[216:219], v[80:83]
  v_mfma_f32_16x16x32_bf16 v[64:67], v[156:159], v[220:223], v[64:67]
  v_mfma_f32_16x16x32_bf16 v[68:71], v[160:163], v[220:223], v[68:71]
  v_mfma_f32_16x16x32_bf16 v[72:75], v[164:167], v[220:223], v[72:75]
  v_mfma_f32_16x16x32_bf16 v[76:79], v[168:171], v[220:223], v[76:79]
  v_mfma_f32_16x16x32_bf16 v[80:83], v[172:175], v[220:223], v[80:83]
  global_load_dwordx4 v[216:219], v12, s[22:23]
  global_load_dwordx4 v[220:223], v12, s[22:23] offset:2048
  s_add_u32 s22, s22, 4096
  s_addc_u32 s23, s23, 0
  s_waitcnt vmcnt(18) lgkmcnt(0)
  s_barrier
  ds_read_b128 v[136:139], v14 offset:20480
  ds_read_b128 v[140:143], v14 offset:21504
  ds_read_b128 v[144:147], v14 offset:22528
  ds_read_b128 v[148:151], v14 offset:23552
  ds_read_b128 v[152:155], v14 offset:24576
  ds_read_b128 v[156:159], v14 offset:25600
  ds_read_b128 v[160:163], v14 offset:26624
  ds_read_b128 v[164:167], v14 offset:27648
  ds_read_b128 v[168:171], v14 offset:28672
  ds_read_b128 v[172:175], v14 offset:29696
  s_add_u32 m0, s25, 0
  s_cmp_ge_u32 s3, 2
  s_cbranch_scc1 L_ow956
  global_load_lds_dwordx4 v14, s[26:27] offset:2048
L_ow956:
  global_load_lds_dwordx4 v14, s[26:27]
  global_load_lds_dwordx4 v14, s[26:27] offset:1024
  s_add_u32 s26, s26, 10240
  s_addc_u32 s27, s27, 0
  v_mfma_f32_16x16x32_bf16 v[64:67], v[96:99], v[224:227], v[64:67]
  v_mfma_f32_16x16x32_bf16 v[68:71], v[100:103], v[224:227], v[68:71]
  v_mfma_f32_16x16x32_bf16 v[72:75], v[104:107], v[224:227], v[72:75]
  v_mfma_f32_16x16x32_bf16 v[76:79], v[108:111], v[224:227], v[76:79]
  v_mfma_f32_16x16x32_bf16 v[80:83], v[112:115], v[224:227], v[80:83]
  v_mfma_f32_16x16x32_bf16 v[64:67], v[116:119], v[228:231], v[64:67]
  v_mfma_f32_16x16x32_bf16 v[68:71], v[120:123], v[228:231], v[68:71]
  v_mfma_f32_16x16x32_bf16 v[72:75], v[124:127], v[228:231], v[72:75]
  v_mfma_f32_16x16x32_bf16 v[76:79], v[128:131], v[228:231], v[76:79]
  v_mfma_f32_16x16x32_bf16 v[80:83], v[132:135], v[228:231], v[80:83]
  global_load_dwordx4 v[224:227], v12, s[22:23]
  global_load_dwordx4 v[228:231], v12, s[22:23] offset:2048
  s_add_u32 s22, s22, 4096
  s_addc_u32 s23, s23, 0
  s_waitcnt vmcnt(18) lgkmcnt(0)
  s_barrier
  ds_read_b128 v[96:99], v14 offset:30720
  ds_read_b128 v[100:103], v14 offset:31744
  ds_read_b128 v[104:107], v14 offset:32768
  ds_read_b128 v[108:111], v14 offset:33792
  ds_read_b128 v[112:115], v14 offset:34816
  ds_read_b128 v[116:119], v14 offset:35840
  ds_read_b128 v[120:123], v14 offset:36864
  ds_read_b128 v[124:127], v14 offset:37888
  ds_read_b128 v[128:131], v14 offset:38912
  ds_read_b128 v[132:135], v14 offset:39936
  s_add_u32 m0, s25, 10240
  s_cmp_ge_u32 s3, 2
  s_cbranch_scc1 L_ow991
  global_load_lds_dwordx4 v14, s[26:27] offset:2048
L_ow991:
  global_load_lds_dwordx4 v14, s[26:27]
  global_load_lds_dwordx4 v14, s[26:27] offset:1024
  s_add_u32 s26, s26, 10240
  s_addc_u32 s27, s27, 0
  v_mfma_f32_16x16x32_bf16 v[64:67], v[136:139], v[232:235], v[64:67]
  v_mfma_f32_16x16x32_bf16 v[68:71], v[140:143], v[232:235], v[68:71]
  v_mfma_f32_16x16x32_bf16 v[72:75], v[144:147], v[232:235], v[72:75]
  v_mfma_f32_16x16x32_bf16 v[76:79], v[148:151], v[232:235], v[76:79]
  v_mfma_f32_16x16x32_bf16 v[80:83], v[152:155], v[232:235], v[80:83]
  v_mfma_f32_16x16x32_bf16 v[64:67], v[156:159], v[236:239], v[64:67]
  v_mfma_f32_16x16x32_bf16 v[68:71], v[160:163], v[236:239], v[68:71]
  v_mfma_f32_16x16x32_bf16 v[72:75], v[164:167], v[236:239], v[72:75]
  v_mfma_f32_16x16x32_bf16 v[76:79], v[168:171], v[236:239], v[76:79]
  v_mfma_f32_16x16x32_bf16 v[80:83], v[172:175], v[236:239], v[80:83]
  global_load_dwordx4 v[232:235], v12, s[22:23]
  global_load_dwordx4 v[236:239], v12, s[22:23] offset:2048
  s_add_u32 s22, s22, 4096
  s_addc_u32 s23, s23, 0
  s_waitcnt vmcnt(18) lgkmcnt(0)
  s_barrier
  ds_read_b128 v[136:139], v15 offset:0
  ds_read_b128 v[140:143], v15 offset:1024
  ds_read_b128 v[144:147], v15 offset:2048
  ds_read_b128 v[148:151], v15 offset:3072
  ds_read_b128 v[152:155], v15 offset:4096
  ds_read_b128 v[156:159], v15 offset:5120
  ds_read_b128 v[160:163], v15 offset:6144
  ds_read_b128 v[164:167], v15 offset:7168
  ds_read_b128 v[168:171], v15 offset:8192
  ds_read_b128 v[172:175], v15 offset:9216
  s_add_u32 m0, s25, 20480
  s_cmp_ge_u32 s3, 2
  s_cbranch_scc1 L_ow1026
  global_load_lds_dwordx4 v14, s[26:27] offset:2048
L_ow1026:
  global_load_lds_dwordx4 v14, s[26:27]
  global_load_lds_dwordx4 v14, s[26:27] offset:1024
  s_add_u32 s26, s26, 10240
  s_addc_u32 s27, s27, 0
  v_mfma_f32_16x16x32_bf16 v[64:67], v[96:99], v[176:179], v[64:67]
  v_mfma_f32_16x16x32_bf16 v[68:71], v[100:103], v[176:179], v[68:71]
  v_mfma_f32_16x16x32_bf16 v[72:75], v[104:107], v[176:179], v[72:75]
  v_mfma_f32_16x16x32_bf16 v[76:79], v[108:111], v[176:179], v[76:79]
  v_mfma_f32_16x16x32_bf16 v[80:83], v[112:115], v[176:179], v[80:83]
  v_mfma_f32_16x16x32_bf16 v[64:67], v[116:119], v[180:183], v[64:67]
  v_mfma_f32_16x16x32_bf16 v[68:71], v[120:123], v[180:183], v[68:71]
  v_mfma_f32_16x16x32_bf16 v[72:75], v[124:127], v[180:183], v[72:75]
  v_mfma_f32_16x16x32_bf16 v[76:79], v[128:131], v[180:183], v[76:79]
  v_mfma_f32_16x16x32_bf16 v[80:83], v[132:135], v[180:183], v[80:83]
  global_load_dwordx4 v[176:179], v12, s[22:23]
  global_load_dwordx4 v[180:183], v12, s[22:23] offset:2048
  s_add_u32 s22, s22, 4096
  s_addc_u32 s23, s23, 0
  s_waitcnt vmcnt(18) lgkmcnt(0)
  s_barrier
  ds_read_b128 v[96:99], v15 offset:10240
  ds_read_b128 v[100:103], v15 offset:11264
  ds_read_b128 v[104:107], v15 offset:12288
  ds_read_b128 v[108:111], v15 offset:13312
  ds_read_b128 v[112:115], v15 offset:14336
  ds_read_b128 v[116:119], v15 offset:15360
  ds_read_b128 v[120:123], v15 offset:16384
  ds_read_b128 v[124:127], v15 offset:17408
  ds_read_b128 v[128:131], v15 offset:18432
  ds_read_b128 v[132:135], v15 offset:19456
  s_add_u32 m0, s25, 30720
  s_cmp_ge_u32 s3, 2
  s_cbranch_scc1 L_ow1061
  global_load_lds_dwordx4 v14, s[26:27] offset:2048
L_ow1061:
  global_load_lds_dwordx4 v14, s[26:27]
  global_load_lds_dwordx4 v14, s[26:27] offset:1024
  s_add_u32 s26, s26, 10240
  s_addc_u32 s27, s27, 0
  v_mfma_f32_16x16x32_bf16 v[64:67], v[136:139], v[184:187], v[64:67]
  v_mfma_f32_16x16x32_bf16 v[68:71], v[140:143], v[184:187], v[68:71]
  v_mfma_f32_16x16x32_bf16 v[72:75], v[144:147], v[184:187], v[72:75]
  v_mfma_f32_16x16x32_bf16 v[76:79], v[148:151], v[184:187], v[76:79]
  v_mfma_f32_16x16x32_bf16 v[80:83], v[152:155], v[184:187], v[80:83]
  v_mfma_f32_16x16x32_bf16 v[64:67], v[156:159], v[188:191], v[64:67]
  v_mfma_f32_16x16x32_bf16 v[68:71], v[160:163], v[188:191], v[68:71]
  v_mfma_f32_16x16x32_bf16 v[72:75], v[164:167], v[188:191], v[72:75]
  v_mfma_f32_16x16x32_bf16 v[76:79], v[168:171], v[188:191], v[76:79]
  v_mfma_f32_16x16x32_bf16 v[80:83], v[172:175], v[188:191], v[80:83]
  global_load_dwordx4 v[184:187], v12, s[22:23]
  global_load_dwordx4 v[188:191], v12, s[22:23] offset:2048
  s_add_u32 s22, s22, 4096
  s_addc_u32 s23, s23, 0
  s_waitcnt vmcnt(18) lgkmcnt(0)
  s_barrier
  ds_read_b128 v[136:139], v15 offset:20480
  ds_read_b128 v[140:143], v15 offset:21504
  ds_read_b128 v[144:147], v15 offset:22528
  ds_read_b128 v[148:151], v15 offset:23552
  ds_read_b128 v[152:155], v15 offset:24576
  ds_read_b128 v[156:159], v15 offset:25600
  ds_read_b128 v[160:163], v15 offset:26624
  ds_read_b128 v[164:167], v15 offset:27648
  ds_read_b128 v[168:171], v15 offset:28672
  ds_read_b128 v[172:175], v15 offset:29696
  s_add_u32 m0, s25, 40960
  s_cmp_ge_u32 s3, 2
  s_cbranch_scc1 L_ow1096
  global_load_lds_dwordx4 v14, s[26:27] offset:2048
L_ow1096:
  global_load_lds_dwordx4 v14, s[26:27]
  global_load_lds_dwordx4 v14, s[26:27] offset:1024
  s_add_u32 s26, s26, 10240
  s_addc_u32 s27, s27, 0
  v_mfma_f32_16x16x32_bf16 v[64:67], v[96:99], v[192:195], v[64:67]
  v_mfma_f32_16x16x32_bf16 v[68:71], v[100:103], v[192:195], v[68:71]
  v_mfma_f32_16x16x32_bf16 v[72:75], v[104:107], v[192:195], v[72:75]
  v_mfma_f32_16x16x32_bf16 v[76:79], v[108:111], v[192:195], v[76:79]
  v_mfma_f32_16x16x32_bf16 v[80:83], v[112:115], v[192:195], v[80:83]
  v_mfma_f32_16x16x32_bf16 v[64:67], v[116:119], v[196:199], v[64:67]
  v_mfma_f32_16x16x32_bf16 v[68:71], v[120:123], v[196:199], v[68:71]
  v_mfma_f32_16x16x32_bf16 v[72:75], v[124:127], v[196:199], v[72:75]
  v_mfma_f32_16x16x32_bf16 v[76:79], v[128:131], v[196:199], v[76:79]
  v_mfma_f32_16x16x32_bf16 v[80:83], v[132:135], v[196:199], v[80:83]
  global_load_dwordx4 v[192:195], v12, s[22:23]
  global_load_dwordx4 v[196:199], v12, s[22:23] offset:2048
  s_add_u32 s22, s22, 4096
  s_addc_u32 s23, s23, 0
  s_waitcnt vmcnt(18) lgkmcnt(0)
  s_barrier
  ds_read_b128 v[96:99], v14 offset:0
  ds_read_b128 v[100:103], v14 offset:1024
  ds_read_b128 v[104:107], v14 offset:2048
  ds_read_b128 v[108:111], v14 offset:3072
  ds_read_b128 v[112:115], v14 offset:4096
  ds_read_b128 v[116:119], v14 offset:5120
  ds_read_b128 v[120:123], v14 offset:6144
  ds_read_b128 v[124:127], v14 offset:7168
  ds_read_b128 v[128:131], v14 offset:8192
  ds_read_b128 v[132:135], v14 offset:9216
  s_add_u32 m0, s25, 51200
  s_cmp_ge_u32 s3, 2
  s_cbranch_scc1 L_ow1131
  global_load_lds_dwordx4 v14, s[26:27] offset:2048
L_ow1131:
  global_load_lds_dwordx4 v14, s[26:27]
  global_load_lds_dwordx4 v14, s[26:27] offset:1024
  s_add_u32 s26, s26, 10240
  s_addc_u32 s27, s27, 0
  v_mfma_f32_16x16x32_bf16 v[64:67], v[136:139], v[200:203], v[64:67]
  v_mfma_f32_16x16x32_bf16 v[68:71], v[140:143], v[200:203], v[68:71]
  v_mfma_f32_16x16x32_bf16 v[72:75], v[144:147], v[200:203], v[72:75]
  v_mfma_f32_16x16x32_bf16 v[76:79], v[148:151], v[200:203], v[76:79]
  v_mfma_f32_16x16x32_bf16 v[80:83], v[152:155], v[200:203], v[80:83]
  v_mfma_f32_16x16x32_bf16 v[64:67], v[156:159], v[204:207], v[64:67]
  v_mfma_f32_16x16x32_bf16 v[68:71], v[160:163], v[204:207], v[68:71]
  v_mfma_f32_16x16x32_bf16 v[72:75], v[164:167], v[204:207], v[72:75]
  v_mfma_f32_16x16x32_bf16 v[76:79], v[168:171], v[204:207], v[76:79]
  v_mfma_f32_16x16x32_bf16 v[80:83], v[172:175], v[204:207], v[80:83]
  global_load_dwordx4 v[200:203], v12, s[22:23]
  global_load_dwordx4 v[204:207], v12, s[22:23] offset:2048
  s_add_u32 s22, s22, 4096
  s_addc_u32 s23, s23, 0
  s_waitcnt vmcnt(18) lgkmcnt(0)
  s_barrier
  ds_read_b128 v[136:139], v14 offset:10240
  ds_read_b128 v[140:143], v14 offset:11264
  ds_read_b128 v[144:147], v14 offset:12288
  ds_read_b128 v[148:151], v14 offset:13312
  ds_read_b128 v[152:155], v14 offset:14336
  ds_read_b128 v[156:159], v14 offset:15360
  ds_read_b128 v[160:163], v14 offset:16384
  ds_read_b128 v[164:167], v14 offset:17408
  ds_read_b128 v[168:171], v14 offset:18432
  ds_read_b128 v[172:175], v14 offset:19456
  s_add_u32 m0, s25, 61440
  s_cmp_ge_u32 s3, 2
  s_cbranch_scc1 L_ow1166
  global_load_lds_dwordx4 v14, s[26:27] offset:2048
L_ow1166:
  global_load_lds_dwordx4 v14, s[26:27]
  global_load_lds_dwordx4 v14, s[26:27] offset:1024
  s_add_u32 s26, s26, 10240
  s_addc_u32 s27, s27, 0
  v_mfma_f32_16x16x32_bf16 v[64:67], v[96:99], v[208:211], v[64:67]
  v_mfma_f32_16x16x32_bf16 v[68:71], v[100:103], v[208:211], v[68:71]
  v_mfma_f32_16x16x32_bf16 v[72:75], v[104:107], v[208:211], v[72:75]
  v_mfma_f32_16x16x32_bf16 v[76:79], v[108:111], v[208:211], v[76:79]
  v_mfma_f32_16x16x32_bf16 v[80:83], v[112:115], v[208:211], v[80:83]
  v_mfma_f32_16x16x32_bf16 v[64:67], v[116:119], v[212:215], v[64:67]
  v_mfma_f32_16x16x32_bf16 v[68:71], v[120:123], v[212:215], v[68:71]
  v_mfma_f32_16x16x32_bf16 v[72:75], v[124:127], v[212:215], v[72:75]
  v_mfma_f32_16x16x32_bf16 v[76:79], v[128:131], v[212:215], v[76:79]
  v_mfma_f32_16x16x32_bf16 v[80:83], v[132:135], v[212:215], v[80:83]
  global_load_dwordx4 v[208:211], v12, s[22:23]
  global_load_dwordx4 v[212:215], v12, s[22:23] offset:2048
  s_add_u32 s22, s22, 4096
  s_addc_u32 s23, s23, 0
  s_waitcnt vmcnt(18) lgkmcnt(0)
  s_barrier
  ds_read_b128 v[96:99], v14 offset:20480
  ds_read_b128 v[100:103], v14 offset:21504
  ds_read_b128 v[104:107], v14 offset:22528
  ds_read_b128 v[108:111], v14 offset:23552
  ds_read_b128 v[112:115], v14 offset:24576
  ds_read_b128 v[116:119], v14 offset:25600
  ds_read_b128 v[120:123], v14 offset:26624
  ds_read_b128 v[124:127], v14 offset:27648
  ds_read_b128 v[128:131], v14 offset:28672
  ds_read_b128 v[132:135], v14 offset:29696
  s_add_u32 m0, s25, 0
  s_cmp_ge_u32 s3, 2
  s_cbranch_scc1 L_ow1201
  global_load_lds_dwordx4 v14, s[26:27] offset:2048
L_ow1201:
  global_load_lds_dwordx4 v14, s[26:27]
  global_load_lds_dwordx4 v14, s[26:27] offset:1024
  s_add_u32 s26, s26, 10240
  s_addc_u32 s27, s27, 0
  v_mfma_f32_16x16x32_bf16 v[64:67], v[136:139], v[216:219], v[64:67]
  v_mfma_f32_16x16x32_bf16 v[68:71], v[140:143], v[216:219], v[68:71]
  v_mfma_f32_16x16x32_bf16 v[72:75], v[144:147], v[216:219], v[72:75]
  v_mfma_f32_16x16x32_bf16 v[76:79], v[148:151], v[216:219], v[76:79]
  v_mfma_f32_16x16x32_bf16 v[80:83], v[152:155], v[216:219], v[80:83]
  v_mfma_f32_16x16x32_bf16 v[64:67], v[156:159], v[220:223], v[64:67]
  v_mfma_f32_16x16x32_bf16 v[68:71], v[160:163], v[220:223], v[68:71]
  v_mfma_f32_16x16x32_bf16 v[72:75], v[164:167], v[220:223], v[72:75]
  v_mfma_f32_16x16x32_bf16 v[76:79], v[168:171], v[220:223], v[76:79]
  v_mfma_f32_16x16x32_bf16 v[80:83], v[172:175], v[220:223], v[80:83]
  s_waitcnt vmcnt(16) lgkmcnt(0)
  s_barrier
  ds_read_b128 v[136:139], v14 offset:30720
  ds_read_b128 v[140:143], v14 offset:31744
  ds_read_b128 v[144:147], v14 offset:32768
  ds_read_b128 v[148:151], v14 offset:33792
  ds_read_b128 v[152:155], v14 offset:34816
  ds_read_b128 v[156:159], v14 offset:35840
  ds_read_b128 v[160:163], v14 offset:36864
  ds_read_b128 v[164:167], v14 offset:37888
  ds_read_b128 v[168:171], v14 offset:38912
  ds_read_b128 v[172:175], v14 offset:39936
  s_add_u32 m0, s25, 10240
  s_cmp_ge_u32 s3, 2
  s_cbranch_scc1 L_ow1232
  global_load_lds_dwordx4 v14, s[26:27] offset:2048
L_ow1232:
  global_load_lds_dwordx4 v14, s[26:27]
  global_load_lds_dwordx4 v14, s[26:27] offset:1024
  s_add_u32 s26, s26, 10240
  s_addc_u32 s27, s27, 0
  v_mfma_f32_16x16x32_bf16 v[64:67], v[96:99], v[224:227], v[64:67]
  v_mfma_f32_16x16x32_bf16 v[68:71], v[100:103], v[224:227], v[68:71]
  v_mfma_f32_16x16x32_bf16 v[72:75], v[104:107], v[224:227], v[72:75]
  v_mfma_f32_16x16x32_bf16 v[76:79], v[108:111], v[224:227], v[76:79]
  v_mfma_f32_16x16x32_bf16 v[80:83], v[112:115], v[224:227], v[80:83]
  v_mfma_f32_16x16x32_bf16 v[64:67], v[116:119], v[228:231], v[64:67]
  v_mfma_f32_16x16x32_bf16 v[68:71], v[120:123], v[228:231], v[68:71]
  v_mfma_f32_16x16x32_bf16 v[72:75], v[124:127], v[228:231], v[72:75]
  v_mfma_f32_16x16x32_bf16 v[76:79], v[128:131], v[228:231], v[76:79]
  v_mfma_f32_16x16x32_bf16 v[80:83], v[132:135], v[228:231], v[80:83]
  s_waitcnt vmcnt(14) lgkmcnt(0)
  s_barrier
  ds_read_b128 v[96:99], v15 offset:0
  ds_read_b128 v[100:103], v15 offset:1024
  ds_read_b128 v[104:107], v15 offset:2048
  ds_read_b128 v[108:111], v15 offset:3072
  ds_read_b128 v[112:115], v15 offset:4096
  ds_read_b128 v[116:119], v15 offset:5120
  ds_read_b128 v[120:123], v15 offset:6144
  ds_read_b128 v[124:127], v15 offset:7168
  ds_read_b128 v[128:131], v15 offset:8192
  ds_read_b128 v[132:135], v15 offset:9216
  v_mfma_f32_16x16x32_bf16 v[64:67], v[136:139], v[232:235], v[64:67]
  v_mfma_f32_16x16x32_bf16 v[68:71], v[140:143], v[232:235], v[68:71]
  v_mfma_f32_16x16x32_bf16 v[72:75], v[144:147], v[232:235], v[72:75]
  v_mfma_f32_16x16x32_bf16 v[76:79], v[148:151], v[232:235], v[76:79]
  v_mfma_f32_16x16x32_bf16 v[80:83], v[152:155], v[232:235], v[80:83]
  v_mfma_f32_16x16x32_bf16 v[64:67], v[156:159], v[236:239], v[64:67]
  v_mfma_f32_16x16x32_bf16 v[68:71], v[160:163], v[236:239], v[68:71]
  v_mfma_f32_16x16x32_bf16 v[72:75], v[164:167], v[236:239], v[72:75]
  v_mfma_f32_16x16x32_bf16 v[76:79], v[168:171], v[236:239], v[76:79]
  v_mfma_f32_16x16x32_bf16 v[80:83], v[172:175], v[236:239], v[80:83]
  s_waitcnt vmcnt(10) lgkmcnt(0)
  s_barrier
  ds_read_b128 v[136:139], v15 offset:10240
  ds_read_b128 v[140:143], v15 offset:11264
  ds_read_b128 v[144:147], v15 offset:12288
  ds_read_b128 v[148:151], v15 offset:13312
  ds_read_b128 v[152:155], v15 offset:14336
  ds_read_b128 v[156:159], v15 offset:15360
  ds_read_b128 v[160:163], v15 offset:16384
  ds_read_b128 v[164:167], v15 offset:17408
  ds_read_b128 v[168:171], v15 offset:18432
  ds_read_b128 v[172:175], v15 offset:19456
  v_mfma_f32_16x16x32_bf16 v[64:67], v[96:99], v[176:179], v[64:67]
  v_mfma_f32_16x16x32_bf16 v[68:71], v[100:103], v[176:179], v[68:71]
  v_mfma_f32_16x16x32_bf16 v[72:75], v[104:107], v[176:179], v[72:75]
  v_mfma_f32_16x16x32_bf16 v[76:79], v[108:111], v[176:179], v[76:79]
  v_mfma_f32_16x16x32_bf16 v[80:83], v[112:115], v[176:179], v[80:83]
  v_mfma_f32_16x16x32_bf16 v[64:67], v[116:119], v[180:183], v[64:67]
  v_mfma_f32_16x16x32_bf16 v[68:71], v[120:123], v[180:183], v[68:71]
  v_mfma_f32_16x16x32_bf16 v[72:75], v[124:127], v[180:183], v[72:75]
  v_mfma_f32_16x16x32_bf16 v[76:79], v[128:131], v[180:183], v[76:79]
  v_mfma_f32_16x16x32_bf16 v[80:83], v[132:135], v[180:183], v[80:83]
  s_waitcnt vmcnt(6) lgkmcnt(0)
  s_barrier
  ds_read_b128 v[96:99], v15 offset:20480
  ds_read_b128 v[100:103], v15 offset:21504
  ds_read_b128 v[104:107], v15 offset:22528
  ds_read_b128 v[108:111], v15 offset:23552
  ds_read_b128 v[112:115], v15 offset:24576
  ds_read_b128 v[116:119], v15 offset:25600
  ds_read_b128 v[120:123], v15 offset:26624
  ds_read_b128 v[124:127], v15 offset:27648
  ds_read_b128 v[128:131], v15 offset:28672
  ds_read_b128 v[132:135], v15 offset:29696
  v_mfma_f32_16x16x32_bf16 v[64:67], v[136:139], v[184:187], v[64:67]
  v_mfma_f32_16x16x32_bf16 v[68:71], v[140:143], v[184:187], v[68:71]
  v_mfma_f32_16x16x32_bf16 v[72:75], v[144:147], v[184:187], v[72:75]
  v_mfma_f32_16x16x32_bf16 v[76:79], v[148:151], v[184:187], v[76:79]
  v_mfma_f32_16x16x32_bf16 v[80:83], v[152:155], v[184:187], v[80:83]
  v_mfma_f32_16x16x32_bf16 v[64:67], v[156:159], v[188:191], v[64:67]
  v_mfma_f32_16x16x32_bf16 v[68:71], v[160:163], v[188:191], v[68:71]
  v_mfma_f32_16x16x32_bf16 v[72:75], v[164:167], v[188:191], v[72:75]
  v_mfma_f32_16x16x32_bf16 v[76:79], v[168:171], v[188:191], v[76:79]
  v_mfma_f32_16x16x32_bf16 v[80:83], v[172:175], v[188:191], v[80:83]
  s_waitcnt vmcnt(2) lgkmcnt(0)
  s_barrier
  ds_read_b128 v[136:139], v14 offset:0
  ds_read_b128 v[140:143], v14 offset:1024
  ds_read_b128 v[144:147], v14 offset:2048
  ds_read_b128 v[148:151], v14 offset:3072
  ds_read_b128 v[152:155], v14 offset:4096
  ds_read_b128 v[156:159], v14 offset:5120
  ds_read_b128 v[160:163], v14 offset:6144
  ds_read_b128 v[164:167], v14 offset:7168
  ds_read_b128 v[168:171], v14 offset:8192
  ds_read_b128 v[172:175], v14 offset:9216
  v_mfma_f32_16x16x32_bf16 v[64:67], v[96:99], v[192:195], v[64:67]
  v_mfma_f32_16x16x32_bf16 v[68:71], v[100:103], v[192:195], v[68:71]
  v_mfma_f32_16x16x32_bf16 v[72:75], v[104:107], v[192:195], v[72:75]
  v_mfma_f32_16x16x32_bf16 v[76:79], v[108:111], v[192:195], v[76:79]
  v_mfma_f32_16x16x32_bf16 v[80:83], v[112:115], v[192:195], v[80:83]
  v_mfma_f32_16x16x32_bf16 v[64:67], v[116:119], v[196:199], v[64:67]
  v_mfma_f32_16x16x32_bf16 v[68:71], v[120:123], v[196:199], v[68:71]
  v_mfma_f32_16x16x32_bf16 v[72:75], v[124:127], v[196:199], v[72:75]
  v_mfma_f32_16x16x32_bf16 v[76:79], v[128:131], v[196:199], v[76:79]
  v_mfma_f32_16x16x32_bf16 v[80:83], v[132:135], v[196:199], v[80:83]
  s_waitcnt vmcnt(0) lgkmcnt(0)
  s_barrier
  ds_read_b128 v[96:99], v14 offset:10240
  ds_read_b128 v[100:103], v14 offset:11264
  ds_read_b128 v[104:107], v14 offset:12288
  ds_read_b128 v[108:111], v14 offset:13312
  ds_read_b128 v[112:115], v14 offset:14336
  ds_read_b128 v[116:119], v14 offset:15360
  ds_read_b128 v[120:123], v14 offset:16384
  ds_read_b128 v[124:127], v14 offset:17408
  ds_read_b128 v[128:131], v14 offset:18432
  ds_read_b128 v[132:135], v14 offset:19456
  v_mfma_f32_16x16x32_bf16 v[64:67], v[136:139], v[200:203], v[64:67]
  v_mfma_f32_16x16x32_bf16 v[68:71], v[140:143], v[200:203], v[68:71]
  v_mfma_f32_16x16x32_bf16 v[72:75], v[144:147], v[200:203], v[72:75]
  v_mfma_f32_16x16x32_bf16 v[76:79], v[148:151], v[200:203], v[76:79]
  v_mfma_f32_16x16x32_bf16 v[80:83], v[152:155], v[200:203], v[80:83]
  v_mfma_f32_16x16x32_bf16 v[64:67], v[156:159], v[204:207], v[64:67]
  v_mfma_f32_16x16x32_bf16 v[68:71], v[160:163], v[204:207], v[68:71]
  v_mfma_f32_16x16x32_bf16 v[72:75], v[164:167], v[204:207], v[72:75]
  v_mfma_f32_16x16x32_bf16 v[76:79], v[168:171], v[204:207], v[76:79]
  v_mfma_f32_16x16x32_bf16 v[80:83], v[172:175], v[204:207], v[80:83]
  s_waitcnt lgkmcnt(0)
  v_mfma_f32_16x16x32_bf16 v[64:67], v[96:99], v[208:211], v[64:67]
  v_mfma_f32_16x16x32_bf16 v[68:71], v[100:103], v[208:211], v[68:71]
  v_mfma_f32_16x16x32_bf16 v[72:75], v[104:107], v[208:211], v[72:75]
  v_mfma_f32_16x16x32_bf16 v[76:79], v[108:111], v[208:211], v[76:79]
  v_mfma_f32_16x16x32_bf16 v[80:83], v[112:115], v[208:211], v[80:83]
  v_mfma_f32_16x16x32_bf16 v[64:67], v[116:119], v[212:215], v[64:67]
  v_mfma_f32_16x16x32_bf16 v[68:71], v[120:123], v[212:215], v[68:71]
  v_mfma_f32_16x16x32_bf16 v[72:75], v[124:127], v[212:215], v[72:75]
  v_mfma_f32_16x16x32_bf16 v[76:79], v[128:131], v[212:215], v[76:79]
  v_mfma_f32_16x16x32_bf16 v[80:83], v[132:135], v[212:215], v[80:83]
  s_waitcnt vmcnt(0)
  s_nop 7
  v_lshlrev_b32 v30, 16, v20
  v_and_b32 v31, 0xffff0000, v20
  v_lshlrev_b32 v32, 16, v21
  v_and_b32 v33, 0xffff0000, v21
  v_add_f32 v64, v64, v30
  v_add_f32 v65, v65, v31
  v_add_f32 v66, v66, v32
  v_add_f32 v67, v67, v33
  v_cvt_pk_bf16_f32 v40, v64, v65
  v_cvt_pk_bf16_f32 v41, v66, v67
  global_store_dwordx2 v2, v[40:41], s[8:9] offset:0
  v_lshlrev_b32 v30, 16, v22
  v_and_b32 v31, 0xffff0000, v22
  v_lshlrev_b32 v32, 16, v23
  v_and_b32 v33, 0xffff0000, v23
  v_add_f32 v68, v68, v30
  v_add_f32 v69, v69, v31
  v_add_f32 v70, v70, v32
  v_add_f32 v71, v71, v33
  v_cvt_pk_bf16_f32 v42, v68, v69
  v_cvt_pk_bf16_f32 v43, v70, v71
  global_store_dwordx2 v2, v[42:43], s[8:9] offset:32
  v_lshlrev_b32 v30, 16, v24
  v_and_b32 v31, 0xffff0000, v24
  v_lshlrev_b32 v32, 16, v25
  v_and_b32 v33, 0xffff0000, v25
  v_add_f32 v72, v72, v30
  v_add_f32 v73, v73, v31
  v_add_f32 v74, v74, v32
  v_add_f32 v75, v75, v33
  v_cvt_pk_bf16_f32 v44, v72, v73
  v_cvt_pk_bf16_f32 v45, v74, v75
  global_store_dwordx2 v2, v[44:45], s[8:9] offset:64
  v_lshlrev_b32 v30, 16, v26
  v_and_b32 v31, 0xffff0000, v26
  v_lshlrev_b32 v32, 16, v27
  v_and_b32 v33, 0xffff0000, v27
  v_add_f32 v76, v76, v30
  v_add_f32 v77, v77, v31
  v_add_f32 v78, v78, v32
  v_add_f32 v79, v79, v33
  v_cvt_pk_bf16_f32 v46, v76, v77
  v_cvt_pk_bf16_f32 v47, v78, v79
  global_store_dwordx2 v2, v[46:47], s[8:9] offset:96
  v_lshlrev_b32 v30, 16, v28
  v_and_b32 v31, 0xffff0000, v28
  v_lshlrev_b32 v32, 16, v29
  v_and_b32 v33, 0xffff0000, v29
  v_add_f32 v80, v80, v30
  v_add_f32 v81, v81, v31
  v_add_f32 v82, v82, v32
  v_add_f32 v83, v83, v33
  v_cvt_pk_bf16_f32 v48, v80, v81
  v_cvt_pk_bf16_f32 v49, v82, v83
  global_store_dwordx2 v2, v[48:49], s[8:9] offset:128
  s_endpgm
L_k3_out_kernel_end:
  s_endpgm
.section .rodata,"a"
.p2align 6
.amdhsa_kernel k0_ln_kv_kernel
  .amdhsa_next_free_vgpr 64
  .amdhsa_next_free_sgpr 100
  .amdhsa_accum_offset 64
  .amdhsa_group_segment_fixed_size 0
  .amdhsa_kernarg_size 96
  .amdhsa_user_sgpr_count 2
  .amdhsa_user_sgpr_kernarg_segment_ptr 1
  .amdhsa_system_sgpr_workgroup_id_x 1
  .amdhsa_float_denorm_mode_32 3
.end_amdhsa_kernel
.p2align 6
.amdhsa_kernel kf_attgu_kernel
  .amdhsa_next_free_vgpr 256
  .amdhsa_next_free_sgpr 100
  .amdhsa_accum_offset 256
  .amdhsa_group_segment_fixed_size 0
  .amdhsa_kernarg_size 96
  .amdhsa_user_sgpr_count 2
  .amdhsa_user_sgpr_kernarg_segment_ptr 1
  .amdhsa_system_sgpr_workgroup_id_x 1
  .amdhsa_float_denorm_mode_32 3
.end_amdhsa_kernel
.p2align 6
.amdhsa_kernel k3_out_kernel
  .amdhsa_next_free_vgpr 256
  .amdhsa_next_free_sgpr 100
  .amdhsa_accum_offset 256
  .amdhsa_group_segment_fixed_size 0
  .amdhsa_kernarg_size 96
  .amdhsa_user_sgpr_count 2
  .amdhsa_user_sgpr_kernarg_segment_ptr 1
  .amdhsa_system_sgpr_workgroup_id_x 1
  .amdhsa_float_denorm_mode_32 3
.end_amdhsa_kernel
```
